```python
import torch

def _softmax(x, axis=-1):
    return torch.softmax(x, dim=axis)
def _gelu(x):
    return torch.nn.functional.gelu(x, approximate="tanh")
def _silu(x):
    return torch.nn.functional.silu(x)
def _sigmoid(x):
    return torch.sigmoid(x)
def _layernorm(x, axis=-1, eps=1e-5):
    m = x.mean(dim=axis, keepdim=True)
    v = x.var(dim=axis, keepdim=True, unbiased=False)
    return (x - m) / torch.sqrt(v + eps)
def _scatter_add(tgt, idx, src, axis=0):
    return tgt.clone().index_add_(axis, idx, src)
def _segment_sum(src, seg, n):
    out = torch.zeros((n,) + src.shape[1:], dtype=src.dtype)
    return out.index_add_(0, seg, src)
def _pad(x, pw):
    flat = tuple(v for pair in reversed(pw) for v in pair)
    return torch.nn.functional.pad(x, flat)

kernel_name = 'concat_heads__ssm_conv_h3__softmax_full_mha__prompt'

def setup_inputs():

    _w = (lambda a: (lambda t: t.to(torch.bfloat16) if t.is_floating_point() else t)(torch.as_tensor(a)))
    def _A_setup():
        B, S, D = 1, 2048, 448
        ks = 4
        return {
            "q": _w((lambda *s: torch.randn(*s, dtype=torch.bfloat16) * 0.05)(B, S, D)),
            "k": _w((lambda *s: torch.randn(*s, dtype=torch.bfloat16) * 0.4)(B, S, D)),
            "v": _w((lambda *s: torch.randn(*s, dtype=torch.bfloat16) * 0.4)(B, S, D)),
            "shift_k": _w((lambda *s: torch.randn(*s, dtype=torch.bfloat16) * 0.4)(D, ks) * 0.5),
            "ssm_k": _w((lambda *s: torch.randn(*s, dtype=torch.bfloat16) * 0.8)(D, S) * (1.0 / S ** 0.5)),
            "ssm_D": _w((lambda *s: torch.randn(*s, dtype=torch.bfloat16) * 0.4)(D)),
        }
    _A_in = _A_setup()

    def _B_setup():
        B, S, D = 1, 2048, 448
        return {
            "x": _w((lambda *s: torch.randn(*s, dtype=torch.bfloat16) * 0.2)(B, S, D)),
            "wqkv": _w((lambda *s: torch.randn(*s, dtype=torch.bfloat16) * 0.2)(D, 3 * D)),
            "wo": _w((lambda *s: torch.randn(*s, dtype=torch.bfloat16) * 0.05)(D, D)),
        }
    _B_in = _B_setup()

    return {
        "A_q": _A_in["q"],
        "A_k": _A_in["k"],
        "A_v": _A_in["v"],
        "A_shift_k": _A_in["shift_k"],
        "A_ssm_k": _A_in["ssm_k"],
        "A_ssm_D": _A_in["ssm_D"],
        "B_x": _B_in["x"],
        "B_wqkv": _B_in["wqkv"],
        "B_wo": _B_in["wo"],
    }

def reference(A_q, A_k, A_v, A_shift_k, A_ssm_k, A_ssm_D, B_x, B_wqkv, B_wo):
    def _A_ref(q, k, v, shift_k, ssm_k, ssm_D):
        B, S, D = q.shape
        ks = shift_k.shape[-1]
        k_pad = _pad(k, ((0, 0), (ks - 1, 0), (0, 0)))
        k_shift = torch.zeros_like(k)
        for t in range(ks):
            k_shift = k_shift + k_pad[:, t:t + S, :] * shift_k[:, ks - 1 - t][None, None, :]
        kv = k_shift * v
        L = 2 * S
        kv_pad = _pad(kv, ((0, 0), (0, S), (0, 0)))
        kf_pad = _pad(ssm_k, ((0, 0), (0, S)))
        kv_f = (lambda x, axes=(-2,-1): torch.fft.rfft2(x.float(), dim=axes))(kv_pad[:, None, :, :], axes=(1, 2))
        kf_f = (lambda x, axes=(-2,-1): torch.fft.rfft2(x.float(), dim=axes))(kf_pad[:, None, :], axes=(1, 2))
        kf_f = (lambda x, *d: x.permute(*d))(kf_f, 1, 2, 0)
        y_f = kv_f * kf_f[None, :, :, :]
        y = (lambda x, s, axes=(-2,-1): torch.fft.irfft2(x, s=s, dim=axes).to(torch.bfloat16))(y_f, (1, L), axes=(1, 2))[:, 0, :S, :]
        y = y + kv * ssm_D[None, None, :]
        return q * y

    def _B_ref(x, wqkv, wo):
        B, S, D = x.shape
        H = 16; Dh = D // H
        qkv = (lambda x, *d: x.permute(*d))((x @ wqkv).reshape(B, S, 3, H, Dh), 2, 0, 3, 1, 4)
        q, k, v = qkv[0], qkv[1], qkv[2]
        scale = Dh ** -0.5
        scores = torch.einsum("bhqd,bhkd->bhqk", q, k) * scale
        p = _softmax(scores, axis=-1)
        o = torch.einsum("bhqk,bhkd->bhqd", p, v)
        return (lambda x, *d: x.permute(*d))(o, 0, 2, 1, 3).reshape(B, S, D) @ wo

    a = _A_ref(A_q, A_k, A_v, A_shift_k, A_ssm_k, A_ssm_D)
    b = _B_ref(B_x, B_wqkv, B_wo)
    return torch.concatenate([a, b], axis=-1)
```

```asm
; @launch grid=(256,1,1) block=(768,1,1) lds=157312
.amdgcn_target "amdgcn-amd-amdhsa--gfx950"
.text
.globl concat_heads__ssm_conv_h3__softmax_full_mha__prompt_kernel
.p2align 8
.type concat_heads__ssm_conv_h3__softmax_full_mha__prompt_kernel,@function
concat_heads__ssm_conv_h3__softmax_full_mha__prompt_kernel:
  s_cmp_ge_u32 s2, 256
  s_cbranch_scc1 L_exit
  s_load_dwordx16 s[64:79], s[0:1], 0
  s_load_dwordx8 s[80:87], s[0:1], 64
  v_lshrrev_b32 v2, 6, v0
  v_and_b32 v1, 63, v0
  v_readfirstlane_b32 s3, v2
  s_and_b32 s52, s2, 7
  s_lshr_b32 s53, s2, 3
  s_lshr_b32 s54, s52, 1
  s_lshl_b32 s54, s54, 2
  s_and_b32 s55, s53, 3
  s_add_u32 s54, s54, s55
  s_and_b32 s55, s52, 1
  s_lshl_b32 s55, s55, 3
  s_lshr_b32 s56, s53, 2
  s_add_u32 s55, s55, s56
  s_cmp_ge_u32 s3, 4
  s_cbranch_scc1 L_notgemm_5
  v_lshlrev_b32 v2, 2, v1
  v_add_u32 v2, 157184, v2
  v_mov_b32 v3, 0
  s_mov_b64 exec, 0xffffffff
  ds_write_b32 v2, v3
  s_mov_b64 exec, -1
  s_cmp_ge_u32 s2, 8
  s_cbranch_scc1 L_nocp_6
  s_getpc_b64 s[96:97]
L_pc_here:
  v_lshlrev_b32 v166, 7, v1
  s_lshl_b32 s58, s3, 13
  v_add_u32 v166, s58, v166
  v_min_u32 v166, L_code_end-L_pc_here-4, v166
  global_load_dword v167, v166, s[96:97]
L_nocp_6:
  s_waitcnt lgkmcnt(0)
  s_cmp_lg_u32 s3, 0
  s_cbranch_scc1 L_notlb_7
  s_lshr_b32 s88, s2, 3
  s_mov_b32 s90, 0
  s_mov_b32 s91, 0
  s_cmp_eq_u32 s88, 0
  s_cselect_b32 s90, s76, s90
  s_cselect_b32 s91, s77, s91
  s_cmp_eq_u32 s88, 1
  s_cselect_b32 s90, s78, s90
  s_cselect_b32 s91, s79, s91
  s_cmp_eq_u32 s88, 2
  s_cselect_b32 s90, s66, s90
  s_cselect_b32 s91, s67, s91
  s_cmp_eq_u32 s88, 3
  s_cselect_b32 s90, s68, s90
  s_cselect_b32 s91, s69, s91
  s_cmp_eq_u32 s88, 4
  s_cselect_b32 s90, s70, s90
  s_cselect_b32 s91, s71, s91
  s_cmp_eq_u32 s88, 5
  s_cselect_b32 s90, s72, s90
  s_cselect_b32 s91, s73, s91
  s_cmp_eq_u32 s88, 6
  s_cselect_b32 s90, s80, s90
  s_cselect_b32 s91, s81, s91
  s_cmp_eq_u32 s88, 7
  s_cselect_b32 s90, s64, s90
  s_cselect_b32 s91, s65, s91
  s_cmp_eq_u32 s88, 8
  s_cselect_b32 s90, s82, s90
  s_cselect_b32 s91, s83, s91
  s_cmp_eq_u32 s88, 9
  s_cselect_b32 s90, s82, s90
  s_cselect_b32 s91, s83, s91
  s_cmp_eq_u32 s88, 10
  s_cselect_b32 s90, s86, s90
  s_cselect_b32 s91, s87, s91
  s_cmp_eq_u32 s88, 11
  s_cselect_b32 s90, s86, s90
  s_cselect_b32 s91, s87, s91
  s_cmp_eq_u32 s88, 12
  s_cselect_b32 s90, s86, s90
  s_cselect_b32 s91, s87, s91
  s_cmp_eq_u32 s88, 13
  s_cselect_b32 s90, s86, s90
  s_cselect_b32 s91, s87, s91
  s_cmp_eq_u32 s88, 14
  s_cselect_b32 s90, s86, s90
  s_cselect_b32 s91, s87, s91
  s_cmp_eq_u32 s88, 15
  s_cselect_b32 s90, s86, s90
  s_cselect_b32 s91, s87, s91
  s_cmp_eq_u32 s88, 16
  s_cselect_b32 s90, s86, s90
  s_cselect_b32 s91, s87, s91
  s_sub_u32 s89, s88, 10
  s_lshl_b32 s89, s89, 21
  s_cmp_ge_u32 s88, 10
  s_cselect_b32 s89, s89, 0
  s_cmp_eq_u32 s88, 9
  s_cselect_b32 s89, 0x200000, s89
  s_cmp_ge_u32 s88, 17
  s_cbranch_scc1 L_notlb_7
  v_mov_b32 v4, s89
  global_load_dword v153, v4, s[90:91] sc1
L_notlb_7:
  s_barrier
  s_branch L_gemmw_2
L_notgemm_5:
  s_cmp_lt_u32 s3, 8
  s_cbranch_scc1 L_helpw_8
L_auxw_3:
  s_and_b32 s57, s2, 7
  s_lshr_b32 s56, s2, 3
  s_lshl_b32 s13, s57, 5
  s_add_u32 s13, s13, s56
  s_cmp_ge_u32 s13, 224
  s_cbranch_scc1 L_auxend_4
  s_sub_u32 s58, s3, 8
  v_lshrrev_b32 v2, 3, v1
  v_and_b32 v3, 7, v1
  s_lshl_b32 s88, s56, 6
  s_lshl_b32 s89, s58, 4
  s_add_u32 s88, s88, s89
  v_add_u32 v4, s88, v2
  v_mul_u32_u24 v5, 896, v4
  v_lshlrev_b32 v6, 4, v3
  s_lshl_b32 s89, s57, 7
  v_add3_u32 v5, v5, v6, s89
  v_subrev_u32 v7, 2688, v5
  v_cmp_gt_u32 vcc, 3, v4
  v_mov_b32 v10, 0x80000000
  s_lshl_b32 s90, s58, 12
  s_add_u32 s90, s90, 114688
  v_cndmask_b32 v8, v7, v10, vcc
  s_waitcnt lgkmcnt(0)
  s_mov_b32 s16, s66
  s_mov_b32 s17, s67
  s_mov_b32 s18, 1835008
  s_mov_b32 s19, 0x00020000
  s_mov_b32 s20, s68
  s_mov_b32 s21, s69
  s_mov_b32 s22, 1835008
  s_mov_b32 s23, 0x00020000
  s_mov_b32 s24, s70
  s_mov_b32 s25, s71
  s_mov_b32 s26, 3584
  s_mov_b32 s27, 0x00020000
  s_mov_b32 m0, s90
  v_lshlrev_b32 v9, 4, v1
  buffer_load_dwordx4 v8, s[16:19], 0 offen lds
  s_add_u32 m0, s90, 1024
  v_add_u32 v11, 7168, v7
  buffer_load_dwordx4 v11, s[16:19], 0 offen lds
  s_add_u32 m0, s90, 2048
  v_add_u32 v11, 14336, v7
  s_mov_b64 exec, 0xffffff
  buffer_load_dwordx4 v11, s[16:19], 0 offen lds
  s_mov_b64 exec, -1
  s_add_u32 m0, s90, 3072
  s_lshl_b32 s89, s57, 9
  buffer_load_dwordx4 v9, s[24:27], s89 offen lds
  buffer_load_dwordx4 v[12:15], v5, s[20:23], 0 offen
  s_movk_i32 s89, 7168
  buffer_load_dwordx4 v[16:19], v5, s[20:23], s89 offen
  s_waitcnt lgkmcnt(0)
  s_mov_b32 s32, s72
  s_mov_b32 s33, s73
  s_mov_b32 s34, 1835008
  s_mov_b32 s35, 0x00020000
  s_mov_b32 s36, s74
  s_mov_b32 s37, s75
  s_mov_b32 s38, 896
  s_mov_b32 s39, 0x00020000
  s_mov_b32 s4, s86
  s_mov_b32 s5, s87
  s_mov_b32 s6, 14680064
  s_mov_b32 s7, 0x00020000
  v_mov_b32 v154, 13647872
  buffer_load_dword v154, v154, s[4:7], 0 offen sc1
  s_lshl_b32 s97, s13, 13
  s_lshl_b32 s98, s58, 10
  s_add_u32 s97, s97, s98
  v_lshlrev_b32 v70, 4, v1
  s_add_u32 m0, s98, 147984
  s_add_u32 s99, s97, 0
  buffer_load_dwordx4 v70, s[32:35], s99 offen lds
  s_add_u32 m0, s98, 152592
  s_add_u32 s99, s97, 4096
  buffer_load_dwordx4 v70, s[32:35], s99 offen lds
  v_and_b32 v71, 1, v1
  v_mul_u32_u24 v71, 4608, v71
  s_cmp_eq_u32 s58, 1
  s_cselect_b32 s99, 4112, 0
  s_add_u32 s99, s99, 147968
  v_add_u32 v71, s99, v71
  v_mov_b32 v72, 0
  v_mov_b32 v73, 0
  v_mov_b32 v74, 0
  v_mov_b32 v75, 0
  s_cmp_ge_u32 s58, 2
  s_cbranch_scc1 L_noz_9
  ds_write_b128 v71, v[72:75]
L_noz_9:
  s_barrier
  v_add_u32 v9, s90, v9
  v_lshlrev_b32 v6, 6, v3
  s_add_u32 s89, s90, 3072
  v_add_u32 v6, s89, v6
  v_lshrrev_b32 v10, 1, v2
  v_and_b32 v10, 1, v10
  v_lshlrev_b32 v10, 2, v10
  v_xor_b32 v10, v10, v3
  v_lshlrev_b32 v10, 4, v10
  v_lshl_add_u32 v10, v2, 7, v10
  v_add_u32 v10, s90, v10
  v_bfe_u32 v11, v1, 2, 2
  v_sub_u32 v11, 3, v11
  v_lshrrev_b32 v49, 4, v1
  v_lshlrev_b32 v49, 1, v49
  v_bfe_u32 v53, v1, 1, 1
  v_add_u32 v49, v49, v53
  v_lshrrev_b32 v53, 1, v11
  v_lshlrev_b32 v53, 2, v53
  v_xor_b32 v49, v49, v53
  v_lshlrev_b32 v49, 4, v49
  v_and_b32 v53, 1, v1
  v_lshl_add_u32 v49, v53, 3, v49
  v_lshl_add_u32 v49, v11, 7, v49
  v_add_u32 v49, s90, v49
  s_mov_b32 s88, 0x05040100
  s_mov_b32 s89, 0x07060302
  s_waitcnt vmcnt(2)
  ds_read_b128 v[32:35], v6 offset:0
  ds_read_b128 v[36:39], v6 offset:16
  ds_read_b128 v[40:43], v6 offset:32
  ds_read_b128 v[44:47], v6 offset:48
  ds_read_b128 v[92:95], v9 offset:384
  ds_read_b128 v[96:99], v9 offset:256
  ds_read_b128 v[100:103], v9 offset:128
  ds_read_b128 v[104:107], v9 offset:0
  v_mov_b32 v108, v12
  v_mov_b32 v109, v13
  v_mov_b32 v110, v14
  v_mov_b32 v111, v15
  ds_read_b128 v[112:115], v9 offset:1408
  ds_read_b128 v[116:119], v9 offset:1280
  ds_read_b128 v[120:123], v9 offset:1152
  ds_read_b128 v[124:127], v9 offset:1024
  v_mov_b32 v128, v16
  v_mov_b32 v129, v17
  v_mov_b32 v130, v18
  v_mov_b32 v131, v19
  s_waitcnt lgkmcnt(0)
  v_perm_b32 v60, v96, v92, s88
  v_perm_b32 v68, v104, v100, s88
  v_perm_b32 v61, v96, v92, s89
  v_perm_b32 v69, v104, v100, s89
  v_perm_b32 v62, v97, v93, s88
  v_perm_b32 v70, v105, v101, s88
  v_perm_b32 v63, v97, v93, s89
  v_perm_b32 v71, v105, v101, s89
  v_perm_b32 v64, v98, v94, s88
  v_perm_b32 v72, v106, v102, s88
  v_perm_b32 v65, v98, v94, s89
  v_perm_b32 v73, v106, v102, s89
  v_perm_b32 v66, v99, v95, s88
  v_perm_b32 v74, v107, v103, s88
  v_perm_b32 v67, v99, v95, s89
  v_perm_b32 v75, v107, v103, s89
  v_dot2_f32_bf16 v76, v60, v32, 0
  v_dot2_f32_bf16 v77, v61, v34, 0
  v_dot2_f32_bf16 v78, v62, v36, 0
  v_dot2_f32_bf16 v79, v63, v38, 0
  v_dot2_f32_bf16 v80, v64, v40, 0
  v_dot2_f32_bf16 v81, v65, v42, 0
  v_dot2_f32_bf16 v82, v66, v44, 0
  v_dot2_f32_bf16 v83, v67, v46, 0
  v_dot2_f32_bf16 v76, v68, v33, v76
  v_dot2_f32_bf16 v77, v69, v35, v77
  v_dot2_f32_bf16 v78, v70, v37, v78
  v_dot2_f32_bf16 v79, v71, v39, v79
  v_dot2_f32_bf16 v80, v72, v41, v80
  v_dot2_f32_bf16 v81, v73, v43, v81
  v_dot2_f32_bf16 v82, v74, v45, v82
  v_dot2_f32_bf16 v83, v75, v47, v83
  v_lshlrev_b32 v60, 16, v108
  v_and_b32 v61, 0xffff0000, v108
  v_lshlrev_b32 v62, 16, v109
  v_and_b32 v63, 0xffff0000, v109
  v_lshlrev_b32 v64, 16, v110
  v_and_b32 v65, 0xffff0000, v110
  v_lshlrev_b32 v66, 16, v111
  v_and_b32 v67, 0xffff0000, v111
  v_mul_f32 v76, v76, v60
  v_mul_f32 v77, v77, v61
  v_mul_f32 v78, v78, v62
  v_mul_f32 v79, v79, v63
  v_mul_f32 v80, v80, v64
  v_mul_f32 v81, v81, v65
  v_mul_f32 v82, v82, v66
  v_mul_f32 v83, v83, v67
  v_cvt_pk_bf16_f32 v84, v76, v77
  v_cvt_pk_bf16_f32 v85, v78, v79
  v_cvt_pk_bf16_f32 v86, v80, v81
  v_cvt_pk_bf16_f32 v87, v82, v83
  ds_write_b128 v10, v[84:87] offset:0
  v_perm_b32 v60, v116, v112, s88
  v_perm_b32 v68, v124, v120, s88
  v_perm_b32 v61, v116, v112, s89
  v_perm_b32 v69, v124, v120, s89
  v_perm_b32 v62, v117, v113, s88
  v_perm_b32 v70, v125, v121, s88
  v_perm_b32 v63, v117, v113, s89
  v_perm_b32 v71, v125, v121, s89
  v_perm_b32 v64, v118, v114, s88
  v_perm_b32 v72, v126, v122, s88
  v_perm_b32 v65, v118, v114, s89
  v_perm_b32 v73, v126, v122, s89
  v_perm_b32 v66, v119, v115, s88
  v_perm_b32 v74, v127, v123, s88
  v_perm_b32 v67, v119, v115, s89
  v_perm_b32 v75, v127, v123, s89
  v_dot2_f32_bf16 v76, v60, v32, 0
  v_dot2_f32_bf16 v77, v61, v34, 0
  v_dot2_f32_bf16 v78, v62, v36, 0
  v_dot2_f32_bf16 v79, v63, v38, 0
  v_dot2_f32_bf16 v80, v64, v40, 0
  v_dot2_f32_bf16 v81, v65, v42, 0
  v_dot2_f32_bf16 v82, v66, v44, 0
  v_dot2_f32_bf16 v83, v67, v46, 0
  v_dot2_f32_bf16 v76, v68, v33, v76
  v_dot2_f32_bf16 v77, v69, v35, v77
  v_dot2_f32_bf16 v78, v70, v37, v78
  v_dot2_f32_bf16 v79, v71, v39, v79
  v_dot2_f32_bf16 v80, v72, v41, v80
  v_dot2_f32_bf16 v81, v73, v43, v81
  v_dot2_f32_bf16 v82, v74, v45, v82
  v_dot2_f32_bf16 v83, v75, v47, v83
  v_lshlrev_b32 v60, 16, v128
  v_and_b32 v61, 0xffff0000, v128
  v_lshlrev_b32 v62, 16, v129
  v_and_b32 v63, 0xffff0000, v129
  v_lshlrev_b32 v64, 16, v130
  v_and_b32 v65, 0xffff0000, v130
  v_lshlrev_b32 v66, 16, v131
  v_and_b32 v67, 0xffff0000, v131
  v_mul_f32 v76, v76, v60
  v_mul_f32 v77, v77, v61
  v_mul_f32 v78, v78, v62
  v_mul_f32 v79, v79, v63
  v_mul_f32 v80, v80, v64
  v_mul_f32 v81, v81, v65
  v_mul_f32 v82, v82, v66
  v_mul_f32 v83, v83, v67
  v_cvt_pk_bf16_f32 v84, v76, v77
  v_cvt_pk_bf16_f32 v85, v78, v79
  v_cvt_pk_bf16_f32 v86, v80, v81
  v_cvt_pk_bf16_f32 v87, v82, v83
  ds_write_b128 v10, v[84:87] offset:1024
  s_waitcnt lgkmcnt(0)
  ds_read_b64_tr_b16 v[60:61], v49 offset:1536
  ds_read_b64_tr_b16 v[62:63], v49 offset:1024
  ds_read_b64_tr_b16 v[64:65], v49 offset:512
  ds_read_b64_tr_b16 v[66:67], v49 offset:0
  s_lshl_b32 s89, s58, 1
  s_sub_u32 s89, 6, s89
  v_xor_b32 v48, s89, v3
  v_xor_b32 v53, 1, v48
  v_lshlrev_b32 v55, 7, v1
  v_add_u32 v55, 131072, v55
  v_lshl_add_u32 v48, v48, 4, v55
  v_lshl_add_u32 v53, v53, 4, v55
  s_waitcnt lgkmcnt(0)
  ds_write_b128 v48, v[60:63]
  ds_write_b128 v53, v[64:67]
  s_waitcnt lgkmcnt(0)
  v_mov_b32 v160, 157196
  v_mov_b32 v161, 1
  s_mov_b64 exec, 1
  ds_add_u32 v160, v161
  s_mov_b64 exec, -1
  v_xor_b32 v48, v3, v2
  s_lshl_b32 s89, s58, 11
  s_add_u32 s89, s89, 131072
  v_lshlrev_b32 v55, 7, v2
  v_lshl_add_u32 v48, v48, 4, v55
  v_add_u32 v48, s89, v48
  s_lshl_b32 s89, s57, 6
  s_lshl_b32 s90, s58, 4
  s_add_u32 s89, s89, s90
  v_add_u32 v53, s89, v2
  v_lshlrev_b32 v53, 12, v53
  v_lshl_add_u32 v53, v3, 4, v53
  s_lshl_b32 s89, s56, 7
  s_sub_u32 s91, 6295424, s89
  s_add_u32 s90, s91, 32768
  s_movk_i32 s95, 3
  s_lshl_b32 s94, s95, 2
  s_add_u32 s94, s94, 157184
  v_mov_b32 v160, s94
  s_mov_b32 s96, 0
L_ls_10:
  ds_read_b32 v161, v160
  s_add_u32 s96, s96, 1
  s_waitcnt lgkmcnt(0)
  v_readfirstlane_b32 s94, v161
  s_cmp_gt_u32 s96, 1048576
  s_cbranch_scc1 L_lsx_11
  s_cmp_ge_u32 s94, 4
  s_cbranch_scc1 L_lsx_11
  s_sleep 1
  s_branch L_ls_10
L_lsx_11:
  ds_read_b128 v[60:63], v48
  ds_read_b128 v[64:67], v48 offset:1024
  s_waitcnt lgkmcnt(0)
  buffer_store_dwordx4 v[60:63], v53, s[4:7], s91 offen sc1
  buffer_store_dwordx4 v[64:67], v53, s[4:7], s90 offen sc1
  s_waitcnt lgkmcnt(0)
  v_mov_b32 v160, 157220
  v_mov_b32 v161, 1
  s_mov_b64 exec, 1
  ds_add_u32 v160, v161
  s_mov_b64 exec, -1
  s_waitcnt lgkmcnt(0)
  v_readfirstlane_b32 s63, v154
  s_nop 3
  s_mul_i32 s93, s63, 0x9E3779B1
  s_add_u32 s93, s93, 0x7F4A7C15
  s_waitcnt vmcnt(2)
  v_mov_b32 v160, 157284
  v_mov_b32 v161, 1
  s_mov_b64 exec, 1
  ds_add_u32 v160, v161
  s_mov_b64 exec, -1
  s_waitcnt vmcnt(0)
  s_lshl_b32 s91, s57, 5
  s_add_u32 s91, s91, s56
  v_mov_b32 v160, 157192
  v_mov_b32 v161, 1
  s_mov_b64 exec, 1
  ds_add_rtn_u32 v161, v160, v161
  s_waitcnt lgkmcnt(0)
  s_mov_b64 exec, -1
  v_readfirstlane_b32 s94, v161
  s_nop 3
  s_cmp_lg_u32 s94, 3
  s_cbranch_scc1 L_sl_12
  s_lshl_b32 s94, s91, 4
  s_add_u32 s94, s94, 13631488
  v_mov_b32 v160, s93
  v_mov_b32 v161, 0
  s_mov_b64 exec, 1
  buffer_store_dword v160, v161, s[4:7], s94 offen sc1
  s_mov_b64 exec, -1
L_sl_12:
  s_movk_i32 s95, 9
  s_lshl_b32 s94, s95, 2
  s_add_u32 s94, s94, 157184
  v_mov_b32 v160, s94
  s_mov_b32 s96, 0
L_ls_13:
  ds_read_b32 v161, v160
  s_add_u32 s96, s96, 1
  s_waitcnt lgkmcnt(0)
  v_readfirstlane_b32 s94, v161
  s_cmp_gt_u32 s96, 1048576
  s_cbranch_scc1 L_lsx_14
  s_cmp_ge_u32 s94, 4
  s_cbranch_scc1 L_lsx_14
  s_sleep 1
  s_branch L_ls_13
L_lsx_14:
  s_movk_i32 s95, 25
  s_lshl_b32 s94, s95, 2
  s_add_u32 s94, s94, 157184
  v_mov_b32 v160, s94
  s_mov_b32 s96, 0
L_ls_15:
  ds_read_b32 v161, v160
  s_add_u32 s96, s96, 1
  s_waitcnt lgkmcnt(0)
  v_readfirstlane_b32 s94, v161
  s_cmp_gt_u32 s96, 1048576
  s_cbranch_scc1 L_lsx_16
  s_cmp_ge_u32 s94, 4
  s_cbranch_scc1 L_lsx_16
  s_sleep 1
  s_branch L_ls_15
L_lsx_16:
  s_lshl_b32 s88, s58, 6
  v_add_u32 v2, s88, v1
  v_lshlrev_b32 v3, 4, v2
  v_add_u32 v4, 147968, v3
  ds_read_b128 v[8:11], v4 offset:0
  ds_read_b128 v[12:15], v4 offset:16
  ds_read_b128 v[20:23], v4 offset:4608
  ds_read_b128 v[24:27], v4 offset:4624
  v_mov_b32 v5, 152064
  ds_read_b128 v[16:19], v5 offset:0
  ds_read_b128 v[28:31], v5 offset:4608
  v_cmp_eq_u32 vcc, 0, v1
  v_mov_b32 v7, 4112
  v_add_u32 v3, 16, v3
  v_cndmask_b32 v7, 0, v7, vcc
  s_waitcnt lgkmcnt(0)
  v_cndmask_b32 v16, 0, v16, vcc
  v_cndmask_b32 v17, 0, v17, vcc
  v_cndmask_b32 v18, 0, v18, vcc
  v_cndmask_b32 v19, 0, v19, vcc
  v_cndmask_b32 v28, 0, v28, vcc
  v_cndmask_b32 v29, 0, v29, vcc
  v_cndmask_b32 v30, 0, v30, vcc
  v_cndmask_b32 v31, 0, v31, vcc
  v_add_u32 v3, 114688, v3
  v_add_u32 v7, 114688, v7
  v_alignbit_b32 v36, v9, v8, 16
  v_alignbit_b32 v37, v10, v9, 16
  v_alignbit_b32 v38, v11, v10, 16
  v_alignbit_b32 v39, v12, v11, 16
  v_alignbit_b32 v40, v10, v9, 16
  v_alignbit_b32 v41, v11, v10, 16
  v_alignbit_b32 v42, v12, v11, 16
  v_alignbit_b32 v43, v13, v12, 16
  v_mov_b32 v44, v9
  v_mov_b32 v45, v10
  v_mov_b32 v46, v11
  v_mov_b32 v47, v12
  ds_write_b128 v3, v[36:39] offset:0
  ds_write_b128 v3, v[44:47] offset:4160
  ds_write_b128 v3, v[40:43] offset:8320
  ds_write_b128 v3, v[10:13] offset:12480
  s_waitcnt lgkmcnt(0)
  v_alignbit_b32 v36, v21, v20, 16
  v_alignbit_b32 v37, v22, v21, 16
  v_alignbit_b32 v38, v23, v22, 16
  v_alignbit_b32 v39, v24, v23, 16
  v_alignbit_b32 v40, v22, v21, 16
  v_alignbit_b32 v41, v23, v22, 16
  v_alignbit_b32 v42, v24, v23, 16
  v_alignbit_b32 v43, v25, v24, 16
  v_mov_b32 v44, v21
  v_mov_b32 v45, v22
  v_mov_b32 v46, v23
  v_mov_b32 v47, v24
  ds_write_b128 v3, v[36:39] offset:16640
  ds_write_b128 v3, v[44:47] offset:20800
  ds_write_b128 v3, v[40:43] offset:24960
  ds_write_b128 v3, v[22:25] offset:29120
  s_waitcnt lgkmcnt(0)
  s_cmp_eq_u32 s58, 3
  s_cbranch_scc0 L_notail_17
  v_mov_b32 v60, v16
  v_mov_b32 v61, v17
  v_mov_b32 v62, v18
  v_mov_b32 v63, v19
  v_mov_b32 v64, 0
  v_mov_b32 v65, 0
  v_mov_b32 v66, 0
  v_mov_b32 v67, 0
  v_alignbit_b32 v36, v61, v60, 16
  v_alignbit_b32 v37, v62, v61, 16
  v_alignbit_b32 v38, v63, v62, 16
  v_alignbit_b32 v39, v64, v63, 16
  v_alignbit_b32 v40, v62, v61, 16
  v_alignbit_b32 v41, v63, v62, 16
  v_alignbit_b32 v42, v64, v63, 16
  v_alignbit_b32 v43, v65, v64, 16
  v_mov_b32 v44, v61
  v_mov_b32 v45, v62
  v_mov_b32 v46, v63
  v_mov_b32 v47, v64
  ds_write_b128 v7, v[36:39] offset:0
  ds_write_b128 v7, v[44:47] offset:4160
  ds_write_b128 v7, v[40:43] offset:8320
  ds_write_b128 v7, v[62:65] offset:12480
  s_waitcnt lgkmcnt(0)
  v_mov_b32 v60, v28
  v_mov_b32 v61, v29
  v_mov_b32 v62, v30
  v_mov_b32 v63, v31
  v_mov_b32 v64, 0
  v_mov_b32 v65, 0
  v_mov_b32 v66, 0
  v_mov_b32 v67, 0
  v_alignbit_b32 v36, v61, v60, 16
  v_alignbit_b32 v37, v62, v61, 16
  v_alignbit_b32 v38, v63, v62, 16
  v_alignbit_b32 v39, v64, v63, 16
  v_alignbit_b32 v40, v62, v61, 16
  v_alignbit_b32 v41, v63, v62, 16
  v_alignbit_b32 v42, v64, v63, 16
  v_alignbit_b32 v43, v65, v64, 16
  v_mov_b32 v44, v61
  v_mov_b32 v45, v62
  v_mov_b32 v46, v63
  v_mov_b32 v47, v64
  ds_write_b128 v7, v[36:39] offset:16640
  ds_write_b128 v7, v[44:47] offset:20800
  ds_write_b128 v7, v[40:43] offset:24960
  ds_write_b128 v7, v[62:65] offset:29120
  s_waitcnt lgkmcnt(0)
L_notail_17:
  v_mov_b32 v160, 157288
  v_mov_b32 v161, 1
  s_mov_b64 exec, 1
  ds_add_u32 v160, v161
  s_mov_b64 exec, -1
  s_movk_i32 s95, 26
  s_lshl_b32 s94, s95, 2
  s_add_u32 s94, s94, 157184
  v_mov_b32 v160, s94
  s_mov_b32 s96, 0
L_ls_18:
  ds_read_b32 v161, v160
  s_add_u32 s96, s96, 1
  s_waitcnt lgkmcnt(0)
  v_readfirstlane_b32 s94, v161
  s_cmp_gt_u32 s96, 1048576
  s_cbranch_scc1 L_lsx_19
  s_cmp_ge_u32 s94, 4
  s_cbranch_scc1 L_lsx_19
  s_sleep 1
  s_branch L_ls_18
L_lsx_19:
  s_lshr_b32 s54, s58, 1
  s_and_b32 s55, s58, 1
  s_lshl_b32 s56, s13, 1
  s_add_u32 s56, s56, s54
  s_lshl_b32 s59, s13, 2
  s_load_dword s60, s[36:37], s59
  v_lshrrev_b32 v4, 4, v1
  v_bfe_u32 v5, v1, 2, 2
  v_and_b32 v6, 3, v1
  v_mul_u32_u24 v5, 4160, v5
  v_lshl_add_u32 v5, v4, 4, v5
  v_lshl_add_u32 v5, v6, 3, v5
  s_mul_i32 s61, s54, 16640
  s_lshl_b32 s62, s55, 8
  s_add_u32 s61, s61, s62
  s_add_u32 s61, s61, 114688
  v_add_u32 v2, s61, v5
  v_and_b32 v6, 15, v1
  v_lshlrev_b32 v7, 5, v6
  v_lshlrev_b32 v5, 4, v4
  v_sub_u32 v5, v5, v7
  s_mul_i32 s61, s54, 4608
  s_add_u32 s61, s61, 148448
  s_add_u32 s61, s61, s62
  v_add_u32 v3, s61, v5
  s_mov_b32 s63, 0
  ds_read_b64_tr_b16 v[40:41], v2 offset:0
  ds_read_b64_tr_b16 v[42:43], v2 offset:8
  ds_read_b64_tr_b16 v[44:45], v2 offset:512
  ds_read_b64_tr_b16 v[46:47], v2 offset:520
  ds_read_b64_tr_b16 v[48:49], v2 offset:1024
  ds_read_b64_tr_b16 v[50:51], v2 offset:1032
  ds_read_b64_tr_b16 v[52:53], v2 offset:1536
  ds_read_b64_tr_b16 v[54:55], v2 offset:1544
  ds_read_b64_tr_b16 v[56:57], v2 offset:2048
  ds_read_b64_tr_b16 v[58:59], v2 offset:2056
  ds_read_b64_tr_b16 v[60:61], v2 offset:2560
  ds_read_b64_tr_b16 v[62:63], v2 offset:2568
  s_waitcnt lgkmcnt(3)
  ds_read_b64_tr_b16 v[64:65], v2 offset:3072
  ds_read_b64_tr_b16 v[66:67], v2 offset:3080
  ds_read_b64_tr_b16 v[68:69], v2 offset:3584
  ds_read_b64_tr_b16 v[70:71], v2 offset:3592
  s_cmp_lg_u32 s3, 8
  s_cbranch_scc1 L_apoll_23
  s_lshr_b32 s88, s13, 5
  s_lshl_b32 s88, s88, 5
  v_and_b32 v8, 31, v1
  v_add_u32 v8, s88, v8
  v_lshlrev_b32 v8, 4, v8
  v_add_u32 v8, 13631488, v8
  s_mov_b32 s94, 0
L_poll_24:
  buffer_load_dword v6, v8, s[4:7], 0 offen sc1
  s_add_u32 s94, s94, 1
  s_cmp_gt_u32 s94, 65536
  s_waitcnt vmcnt(0)
  s_cbranch_scc1 L_pollx_25
  v_cmp_ne_u32 vcc, s93, v6
  s_cbranch_vccz L_pollx_25
  s_sleep 1
  s_branch L_poll_24
L_pollx_25:
  v_mov_b32 v4, 157228
  v_mov_b32 v5, 1
  s_mov_b64 exec, 1
  ds_add_u32 v4, v5
  s_mov_b64 exec, -1
L_apoll_23:
  s_movk_i32 s95, 11
  s_lshl_b32 s94, s95, 2
  s_add_u32 s94, s94, 157184
  v_mov_b32 v4, s94
  s_mov_b32 s96, 0
L_ls_26:
  ds_read_b32 v5, v4
  s_add_u32 s96, s96, 1
  s_waitcnt lgkmcnt(0)
  v_readfirstlane_b32 s94, v5
  s_cmp_gt_u32 s96, 1048576
  s_cbranch_scc1 L_lsx_27
  s_cmp_ge_u32 s94, 1
  s_cbranch_scc1 L_lsx_27
  s_sleep 1
  s_branch L_ls_26
L_lsx_27:
  s_sub_u32 s88, s3, 8
  s_lshl_b32 s89, s88, 10
  s_lshl_b32 s90, s13, 13
  s_add_u32 s90, s90, s89
  s_add_u32 s90, s90, 6291456
  v_lshlrev_b32 v8, 4, v1
  s_add_u32 m0, s89, 147968
  s_add_u32 s91, s90, 0
  buffer_load_dwordx4 v8, s[4:7], s91 offen sc1 lds
  s_add_u32 m0, s89, 152576
  s_add_u32 s91, s90, 4096
  buffer_load_dwordx4 v8, s[4:7], s91 offen sc1 lds
  s_cmp_lt_u32 s88, 2
  s_cbranch_scc0 L_nopad_28
  v_and_b32 v9, 31, v1
  v_lshlrev_b32 v9, 4, v9
  s_mul_i32 s91, s88, 4608
  s_add_u32 s91, s91, 152064
  v_add_u32 v9, s91, v9
  v_mov_b32 v10, 0
  v_mov_b32 v11, 0
  v_mov_b32 v12, 0
  v_mov_b32 v13, 0
  ds_write_b128 v9, v[10:13]
  s_waitcnt lgkmcnt(0)
L_nopad_28:
  s_waitcnt vmcnt(0) lgkmcnt(0)
  v_mov_b32 v4, 157216
  v_mov_b32 v5, 1
  s_mov_b64 exec, 1
  ds_add_u32 v4, v5
  s_mov_b64 exec, -1
  s_movk_i32 s95, 8
  s_lshl_b32 s94, s95, 2
  s_add_u32 s94, s94, 157184
  v_mov_b32 v4, s94
  s_mov_b32 s96, 0
L_ls_29:
  ds_read_b32 v5, v4
  s_add_u32 s96, s96, 1
  s_waitcnt lgkmcnt(0)
  v_readfirstlane_b32 s94, v5
  s_cmp_gt_u32 s96, 1048576
  s_cbranch_scc1 L_lsx_30
  s_cmp_ge_u32 s94, 4
  s_cbranch_scc1 L_lsx_30
  s_sleep 1
  s_branch L_ls_29
L_lsx_30:
L_cvpass_20:
  ds_read_b128 v[72:75], v3 offset:3584
  ds_read_b128 v[76:79], v3 offset:3072
  ds_read_b128 v[80:83], v3 offset:2560
  ds_read_b128 v[84:87], v3 offset:2048
  ds_read_b128 v[88:91], v3 offset:1536
  ds_read_b128 v[92:95], v3 offset:1024
  ds_read_b128 v[96:99], v3 offset:512
  ds_read_b128 v[100:103], v3 offset:0
  v_mov_b32 v8, 0
  v_mov_b32 v9, 0
  v_mov_b32 v10, 0
  v_mov_b32 v11, 0
  v_mov_b32 v12, 0
  v_mov_b32 v13, 0
  v_mov_b32 v14, 0
  v_mov_b32 v15, 0
  v_mov_b32 v16, 0
  v_mov_b32 v17, 0
  v_mov_b32 v18, 0
  v_mov_b32 v19, 0
  v_mov_b32 v20, 0
  v_mov_b32 v21, 0
  v_mov_b32 v22, 0
  v_mov_b32 v23, 0
  v_mov_b32 v24, 0
  v_mov_b32 v25, 0
  v_mov_b32 v26, 0
  v_mov_b32 v27, 0
  v_mov_b32 v28, 0
  v_mov_b32 v29, 0
  v_mov_b32 v30, 0
  v_mov_b32 v31, 0
  v_mov_b32 v32, 0
  v_mov_b32 v33, 0
  v_mov_b32 v34, 0
  v_mov_b32 v35, 0
  v_mov_b32 v36, 0
  v_mov_b32 v37, 0
  v_mov_b32 v38, 0
  v_mov_b32 v39, 0
  s_lshl_b32 s61, s63, 0
  s_sub_u32 s61, 2, s63
L_cvit_21:
  s_waitcnt lgkmcnt(0)
  v_mfma_f32_16x16x32_bf16 v[8:11], v[40:43], v[72:75], v[8:11]
  ds_read_b64_tr_b16 v[104:105], v2 offset:64
  v_mfma_f32_16x16x32_bf16 v[12:15], v[40:43], v[76:79], v[12:15]
  ds_read_b64_tr_b16 v[106:107], v2 offset:72
  v_mfma_f32_16x16x32_bf16 v[16:19], v[40:43], v[80:83], v[16:19]
  v_mfma_f32_16x16x32_bf16 v[20:23], v[40:43], v[84:87], v[20:23]
  ds_read_b128 v[136:139], v3 offset:3648
  v_mfma_f32_16x16x32_bf16 v[24:27], v[40:43], v[88:91], v[24:27]
  ds_read_b64_tr_b16 v[108:109], v2 offset:576
  v_mfma_f32_16x16x32_bf16 v[28:31], v[40:43], v[92:95], v[28:31]
  v_mfma_f32_16x16x32_bf16 v[32:35], v[40:43], v[96:99], v[32:35]
  ds_read_b64_tr_b16 v[110:111], v2 offset:584
  v_mfma_f32_16x16x32_bf16 v[36:39], v[40:43], v[100:103], v[36:39]
  ds_read_b128 v[140:143], v3 offset:3136
  v_mfma_f32_16x16x32_bf16 v[12:15], v[44:47], v[72:75], v[12:15]
  v_mfma_f32_16x16x32_bf16 v[16:19], v[44:47], v[76:79], v[16:19]
  ds_read_b64_tr_b16 v[112:113], v2 offset:1088
  v_mfma_f32_16x16x32_bf16 v[20:23], v[44:47], v[80:83], v[20:23]
  ds_read_b64_tr_b16 v[114:115], v2 offset:1096
  v_mfma_f32_16x16x32_bf16 v[24:27], v[44:47], v[84:87], v[24:27]
  v_mfma_f32_16x16x32_bf16 v[28:31], v[44:47], v[88:91], v[28:31]
  ds_read_b128 v[144:147], v3 offset:2624
  v_mfma_f32_16x16x32_bf16 v[32:35], v[44:47], v[92:95], v[32:35]
  ds_read_b64_tr_b16 v[116:117], v2 offset:1600
  v_mfma_f32_16x16x32_bf16 v[36:39], v[44:47], v[96:99], v[36:39]
  v_mfma_f32_16x16x32_bf16 v[16:19], v[48:51], v[72:75], v[16:19]
  ds_read_b64_tr_b16 v[118:119], v2 offset:1608
  v_mfma_f32_16x16x32_bf16 v[20:23], v[48:51], v[76:79], v[20:23]
  ds_read_b128 v[148:151], v3 offset:2112
  v_mfma_f32_16x16x32_bf16 v[24:27], v[48:51], v[80:83], v[24:27]
  v_mfma_f32_16x16x32_bf16 v[28:31], v[48:51], v[84:87], v[28:31]
  ds_read_b64_tr_b16 v[120:121], v2 offset:2112
  v_mfma_f32_16x16x32_bf16 v[32:35], v[48:51], v[88:91], v[32:35]
  ds_read_b64_tr_b16 v[122:123], v2 offset:2120
  v_mfma_f32_16x16x32_bf16 v[36:39], v[48:51], v[92:95], v[36:39]
  v_mfma_f32_16x16x32_bf16 v[20:23], v[52:55], v[72:75], v[20:23]
  ds_read_b128 v[152:155], v3 offset:1600
  v_mfma_f32_16x16x32_bf16 v[24:27], v[52:55], v[76:79], v[24:27]
  ds_read_b64_tr_b16 v[124:125], v2 offset:2624
  v_mfma_f32_16x16x32_bf16 v[28:31], v[52:55], v[80:83], v[28:31]
  v_mfma_f32_16x16x32_bf16 v[32:35], v[52:55], v[84:87], v[32:35]
  ds_read_b64_tr_b16 v[126:127], v2 offset:2632
  v_mfma_f32_16x16x32_bf16 v[36:39], v[52:55], v[88:91], v[36:39]
  ds_read_b128 v[156:159], v3 offset:1088
  v_mfma_f32_16x16x32_bf16 v[24:27], v[56:59], v[72:75], v[24:27]
  v_mfma_f32_16x16x32_bf16 v[28:31], v[56:59], v[76:79], v[28:31]
  ds_read_b64_tr_b16 v[128:129], v2 offset:3136
  v_mfma_f32_16x16x32_bf16 v[32:35], v[56:59], v[80:83], v[32:35]
  ds_read_b64_tr_b16 v[130:131], v2 offset:3144
  v_mfma_f32_16x16x32_bf16 v[36:39], v[56:59], v[84:87], v[36:39]
  v_mfma_f32_16x16x32_bf16 v[28:31], v[60:63], v[72:75], v[28:31]
  ds_read_b128 v[160:163], v3 offset:576
  v_mfma_f32_16x16x32_bf16 v[32:35], v[60:63], v[76:79], v[32:35]
  ds_read_b64_tr_b16 v[132:133], v2 offset:3648
  v_mfma_f32_16x16x32_bf16 v[36:39], v[60:63], v[80:83], v[36:39]
  v_mfma_f32_16x16x32_bf16 v[32:35], v[64:67], v[72:75], v[32:35]
  ds_read_b64_tr_b16 v[134:135], v2 offset:3656
  v_mfma_f32_16x16x32_bf16 v[36:39], v[64:67], v[76:79], v[36:39]
  ds_read_b128 v[164:167], v3 offset:64
  v_mfma_f32_16x16x32_bf16 v[36:39], v[68:71], v[72:75], v[36:39]
  s_waitcnt lgkmcnt(0)
  v_mfma_f32_16x16x32_bf16 v[8:11], v[104:107], v[136:139], v[8:11]
  ds_read_b64_tr_b16 v[40:41], v2 offset:128
  v_mfma_f32_16x16x32_bf16 v[12:15], v[104:107], v[140:143], v[12:15]
  ds_read_b64_tr_b16 v[42:43], v2 offset:136
  v_mfma_f32_16x16x32_bf16 v[16:19], v[104:107], v[144:147], v[16:19]
  v_mfma_f32_16x16x32_bf16 v[20:23], v[104:107], v[148:151], v[20:23]
  ds_read_b128 v[72:75], v3 offset:3712
  v_mfma_f32_16x16x32_bf16 v[24:27], v[104:107], v[152:155], v[24:27]
  ds_read_b64_tr_b16 v[44:45], v2 offset:640
  v_mfma_f32_16x16x32_bf16 v[28:31], v[104:107], v[156:159], v[28:31]
  v_mfma_f32_16x16x32_bf16 v[32:35], v[104:107], v[160:163], v[32:35]
  ds_read_b64_tr_b16 v[46:47], v2 offset:648
  v_mfma_f32_16x16x32_bf16 v[36:39], v[104:107], v[164:167], v[36:39]
  ds_read_b128 v[76:79], v3 offset:3200
  v_mfma_f32_16x16x32_bf16 v[12:15], v[108:111], v[136:139], v[12:15]
  v_mfma_f32_16x16x32_bf16 v[16:19], v[108:111], v[140:143], v[16:19]
  ds_read_b64_tr_b16 v[48:49], v2 offset:1152
  v_mfma_f32_16x16x32_bf16 v[20:23], v[108:111], v[144:147], v[20:23]
  ds_read_b64_tr_b16 v[50:51], v2 offset:1160
  v_mfma_f32_16x16x32_bf16 v[24:27], v[108:111], v[148:151], v[24:27]
  v_mfma_f32_16x16x32_bf16 v[28:31], v[108:111], v[152:155], v[28:31]
  ds_read_b128 v[80:83], v3 offset:2688
  v_mfma_f32_16x16x32_bf16 v[32:35], v[108:111], v[156:159], v[32:35]
  ds_read_b64_tr_b16 v[52:53], v2 offset:1664
  v_mfma_f32_16x16x32_bf16 v[36:39], v[108:111], v[160:163], v[36:39]
  v_mfma_f32_16x16x32_bf16 v[16:19], v[112:115], v[136:139], v[16:19]
  ds_read_b64_tr_b16 v[54:55], v2 offset:1672
  v_mfma_f32_16x16x32_bf16 v[20:23], v[112:115], v[140:143], v[20:23]
  ds_read_b128 v[84:87], v3 offset:2176
  v_mfma_f32_16x16x32_bf16 v[24:27], v[112:115], v[144:147], v[24:27]
  v_mfma_f32_16x16x32_bf16 v[28:31], v[112:115], v[148:151], v[28:31]
  ds_read_b64_tr_b16 v[56:57], v2 offset:2176
  v_mfma_f32_16x16x32_bf16 v[32:35], v[112:115], v[152:155], v[32:35]
  ds_read_b64_tr_b16 v[58:59], v2 offset:2184
  v_mfma_f32_16x16x32_bf16 v[36:39], v[112:115], v[156:159], v[36:39]
  v_mfma_f32_16x16x32_bf16 v[20:23], v[116:119], v[136:139], v[20:23]
  ds_read_b128 v[88:91], v3 offset:1664
  v_mfma_f32_16x16x32_bf16 v[24:27], v[116:119], v[140:143], v[24:27]
  ds_read_b64_tr_b16 v[60:61], v2 offset:2688
  v_mfma_f32_16x16x32_bf16 v[28:31], v[116:119], v[144:147], v[28:31]
  v_mfma_f32_16x16x32_bf16 v[32:35], v[116:119], v[148:151], v[32:35]
  ds_read_b64_tr_b16 v[62:63], v2 offset:2696
  v_mfma_f32_16x16x32_bf16 v[36:39], v[116:119], v[152:155], v[36:39]
  ds_read_b128 v[92:95], v3 offset:1152
  v_mfma_f32_16x16x32_bf16 v[24:27], v[120:123], v[136:139], v[24:27]
  v_mfma_f32_16x16x32_bf16 v[28:31], v[120:123], v[140:143], v[28:31]
  ds_read_b64_tr_b16 v[64:65], v2 offset:3200
  v_mfma_f32_16x16x32_bf16 v[32:35], v[120:123], v[144:147], v[32:35]
  ds_read_b64_tr_b16 v[66:67], v2 offset:3208
  v_mfma_f32_16x16x32_bf16 v[36:39], v[120:123], v[148:151], v[36:39]
  v_mfma_f32_16x16x32_bf16 v[28:31], v[124:127], v[136:139], v[28:31]
  ds_read_b128 v[96:99], v3 offset:640
  v_mfma_f32_16x16x32_bf16 v[32:35], v[124:127], v[140:143], v[32:35]
  ds_read_b64_tr_b16 v[68:69], v2 offset:3712
  v_mfma_f32_16x16x32_bf16 v[36:39], v[124:127], v[144:147], v[36:39]
  v_mfma_f32_16x16x32_bf16 v[32:35], v[128:131], v[136:139], v[32:35]
  ds_read_b64_tr_b16 v[70:71], v2 offset:3720
  v_mfma_f32_16x16x32_bf16 v[36:39], v[128:131], v[140:143], v[36:39]
  ds_read_b128 v[100:103], v3 offset:128
  v_mfma_f32_16x16x32_bf16 v[36:39], v[132:135], v[136:139], v[36:39]
  v_add_u32 v2, 128, v2
  v_add_u32 v3, 128, v3
  s_sub_u32 s61, s61, 1
  s_cmp_lg_u32 s61, 0
  s_cbranch_scc1 L_cvit_21
  s_waitcnt lgkmcnt(0)
  s_cmp_eq_u32 s63, 0
  s_cbranch_scc1 L_cvreal_22
  s_mov_b32 s63, 0
  v_subrev_u32 v2, 128, v2
  v_subrev_u32 v3, 128, v3
  s_cmp_lg_u32 s3, 8
  s_cbranch_scc1 L_apoll_31
  s_lshr_b32 s88, s13, 5
  s_lshl_b32 s88, s88, 5
  v_and_b32 v8, 31, v1
  v_add_u32 v8, s88, v8
  v_lshlrev_b32 v8, 4, v8
  v_add_u32 v8, 13631488, v8
  s_mov_b32 s94, 0
L_poll_32:
  buffer_load_dword v6, v8, s[4:7], 0 offen sc1
  s_add_u32 s94, s94, 1
  s_cmp_gt_u32 s94, 65536
  s_waitcnt vmcnt(0)
  s_cbranch_scc1 L_pollx_33
  v_cmp_ne_u32 vcc, s93, v6
  s_cbranch_vccz L_pollx_33
  s_sleep 1
  s_branch L_poll_32
L_pollx_33:
  v_mov_b32 v4, 157228
  v_mov_b32 v5, 1
  s_mov_b64 exec, 1
  ds_add_u32 v4, v5
  s_mov_b64 exec, -1
L_apoll_31:
  s_movk_i32 s95, 11
  s_lshl_b32 s94, s95, 2
  s_add_u32 s94, s94, 157184
  v_mov_b32 v4, s94
  s_mov_b32 s96, 0
L_ls_34:
  ds_read_b32 v5, v4
  s_add_u32 s96, s96, 1
  s_waitcnt lgkmcnt(0)
  v_readfirstlane_b32 s94, v5
  s_cmp_gt_u32 s96, 1048576
  s_cbranch_scc1 L_lsx_35
  s_cmp_ge_u32 s94, 1
  s_cbranch_scc1 L_lsx_35
  s_sleep 1
  s_branch L_ls_34
L_lsx_35:
  s_sub_u32 s88, s3, 8
  s_lshl_b32 s89, s88, 10
  s_lshl_b32 s90, s13, 13
  s_add_u32 s90, s90, s89
  s_add_u32 s90, s90, 6291456
  v_lshlrev_b32 v8, 4, v1
  s_add_u32 m0, s89, 147968
  s_add_u32 s91, s90, 0
  buffer_load_dwordx4 v8, s[4:7], s91 offen sc1 lds
  s_add_u32 m0, s89, 152576
  s_add_u32 s91, s90, 4096
  buffer_load_dwordx4 v8, s[4:7], s91 offen sc1 lds
  s_cmp_lt_u32 s88, 2
  s_cbranch_scc0 L_nopad_36
  v_and_b32 v9, 31, v1
  v_lshlrev_b32 v9, 4, v9
  s_mul_i32 s91, s88, 4608
  s_add_u32 s91, s91, 152064
  v_add_u32 v9, s91, v9
  v_mov_b32 v10, 0
  v_mov_b32 v11, 0
  v_mov_b32 v12, 0
  v_mov_b32 v13, 0
  ds_write_b128 v9, v[10:13]
  s_waitcnt lgkmcnt(0)
L_nopad_36:
  s_waitcnt vmcnt(0) lgkmcnt(0)
  v_mov_b32 v4, 157216
  v_mov_b32 v5, 1
  s_mov_b64 exec, 1
  ds_add_u32 v4, v5
  s_mov_b64 exec, -1
  s_movk_i32 s95, 8
  s_lshl_b32 s94, s95, 2
  s_add_u32 s94, s94, 157184
  v_mov_b32 v4, s94
  s_mov_b32 s96, 0
L_ls_37:
  ds_read_b32 v5, v4
  s_add_u32 s96, s96, 1
  s_waitcnt lgkmcnt(0)
  v_readfirstlane_b32 s94, v5
  s_cmp_gt_u32 s96, 1048576
  s_cbranch_scc1 L_lsx_38
  s_cmp_ge_u32 s94, 4
  s_cbranch_scc1 L_lsx_38
  s_sleep 1
  s_branch L_ls_37
L_lsx_38:
  s_branch L_cvpass_20
L_cvreal_22:
  s_nop 7
  v_lshlrev_b32 v104, 4, v1
  s_lshl_b32 s61, s58, 12
  s_add_u32 s61, s61, 65536
  v_add_u32 v105, s61, v104
  s_xor_b32 s62, s58, 1
  s_lshl_b32 s62, s62, 12
  s_add_u32 s62, s62, 65536
  v_add_u32 v106, s62, v104
  s_movk_i32 s95, 24
  s_lshl_b32 s94, s95, 2
  s_add_u32 s94, s94, 157184
  v_mov_b32 v4, s94
  s_mov_b32 s96, 0
L_ls_39:
  ds_read_b32 v5, v4
  s_add_u32 s96, s96, 1
  s_waitcnt lgkmcnt(0)
  v_readfirstlane_b32 s94, v5
  s_cmp_gt_u32 s96, 1048576
  s_cbranch_scc1 L_lsx_40
  s_cmp_ge_u32 s94, 4
  s_cbranch_scc1 L_lsx_40
  s_sleep 1
  s_branch L_ls_39
L_lsx_40:
  s_cmp_eq_u32 s55, 0
  s_cbranch_scc0 L_g1_41
  ds_write_b128 v105, v[24:27] offset:0
  ds_write_b128 v105, v[28:31] offset:1024
  ds_write_b128 v105, v[32:35] offset:2048
  ds_write_b128 v105, v[36:39] offset:3072
  s_branch L_g2_42
L_g1_41:
  ds_write_b128 v105, v[8:11] offset:0
  ds_write_b128 v105, v[12:15] offset:1024
  ds_write_b128 v105, v[16:19] offset:2048
  ds_write_b128 v105, v[20:23] offset:3072
  s_waitcnt lgkmcnt(0)
  v_mov_b32 v8, v24
  v_mov_b32 v9, v25
  v_mov_b32 v10, v26
  v_mov_b32 v11, v27
  v_mov_b32 v12, v28
  v_mov_b32 v13, v29
  v_mov_b32 v14, v30
  v_mov_b32 v15, v31
  v_mov_b32 v16, v32
  v_mov_b32 v17, v33
  v_mov_b32 v18, v34
  v_mov_b32 v19, v35
  v_mov_b32 v20, v36
  v_mov_b32 v21, v37
  v_mov_b32 v22, v38
  v_mov_b32 v23, v39
L_g2_42:
  s_waitcnt lgkmcnt(0)
  v_mov_b32 v4, 157204
  v_mov_b32 v5, 1
  s_mov_b64 exec, 1
  ds_add_u32 v4, v5
  s_mov_b64 exec, -1
  v_and_b32 v107, 15, v1
  v_lshrrev_b32 v108, 4, v1
  v_lshlrev_b32 v109, 5, v107
  v_lshl_add_u32 v109, v108, 3, v109
  s_mul_i32 s61, s54, 4608
  s_add_u32 s61, s61, 150520
  s_lshl_b32 s62, s55, 11
  s_sub_u32 s61, s61, s62
  v_sub_u32 v110, s61, v109
  ds_read_b64 v[80:81], v110 offset:1536
  ds_read_b64 v[82:83], v110 offset:1024
  ds_read_b64 v[84:85], v110 offset:512
  ds_read_b64 v[86:87], v110 offset:0
  s_movk_i32 s95, 5
  s_lshl_b32 s94, s95, 2
  s_add_u32 s94, s94, 157184
  v_mov_b32 v4, s94
  s_mov_b32 s96, 0
L_ls_43:
  ds_read_b32 v5, v4
  s_add_u32 s96, s96, 1
  s_waitcnt lgkmcnt(0)
  v_readfirstlane_b32 s94, v5
  s_cmp_gt_u32 s96, 1048576
  s_cbranch_scc1 L_lsx_44
  s_cmp_ge_u32 s94, 4
  s_cbranch_scc1 L_lsx_44
  s_sleep 1
  s_branch L_ls_43
L_lsx_44:
  ds_read_b128 v[64:67], v106 offset:0
  ds_read_b128 v[68:71], v106 offset:1024
  ds_read_b128 v[72:75], v106 offset:2048
  ds_read_b128 v[76:79], v106 offset:3072
  s_waitcnt lgkmcnt(0)
  s_cmp_eq_u32 s54, 0
  s_cselect_b32 s61, 16, 0
  s_lshl_b32 s60, s60, s61
  s_and_b32 s60, s60, 0xffff0000
  s_lshl_b32 s61, s56, 12
  s_lshl_b32 s62, s55, 11
  s_add_u32 s61, s61, s62
  s_add_u32 s61, s61, 8388608
  v_add_f32 v8, v8, v64
  v_add_f32 v9, v9, v65
  v_add_f32 v10, v10, v66
  v_add_f32 v11, v11, v67
  v_and_b32 v112, 0xffff0000, v81
  v_lshlrev_b32 v113, 16, v81
  v_and_b32 v114, 0xffff0000, v80
  v_lshlrev_b32 v115, 16, v80
  v_fma_f32 v8, v112, s60, v8
  v_fma_f32 v9, v113, s60, v9
  v_fma_f32 v10, v114, s60, v10
  v_fma_f32 v11, v115, s60, v11
  v_cvt_pk_bf16_f32 v116, v8, v9
  v_cvt_pk_bf16_f32 v117, v10, v11
  buffer_store_dwordx2 v[116:117], v109, s[4:7], s61 offen offset:0 sc1
  v_add_f32 v12, v12, v68
  v_add_f32 v13, v13, v69
  v_add_f32 v14, v14, v70
  v_add_f32 v15, v15, v71
  v_and_b32 v112, 0xffff0000, v83
  v_lshlrev_b32 v113, 16, v83
  v_and_b32 v114, 0xffff0000, v82
  v_lshlrev_b32 v115, 16, v82
  v_fma_f32 v12, v112, s60, v12
  v_fma_f32 v13, v113, s60, v13
  v_fma_f32 v14, v114, s60, v14
  v_fma_f32 v15, v115, s60, v15
  v_cvt_pk_bf16_f32 v118, v12, v13
  v_cvt_pk_bf16_f32 v119, v14, v15
  buffer_store_dwordx2 v[118:119], v109, s[4:7], s61 offen offset:512 sc1
  v_add_f32 v16, v16, v72
  v_add_f32 v17, v17, v73
  v_add_f32 v18, v18, v74
  v_add_f32 v19, v19, v75
  v_and_b32 v112, 0xffff0000, v85
  v_lshlrev_b32 v113, 16, v85
  v_and_b32 v114, 0xffff0000, v84
  v_lshlrev_b32 v115, 16, v84
  v_fma_f32 v16, v112, s60, v16
  v_fma_f32 v17, v113, s60, v17
  v_fma_f32 v18, v114, s60, v18
  v_fma_f32 v19, v115, s60, v19
  v_cvt_pk_bf16_f32 v120, v16, v17
  v_cvt_pk_bf16_f32 v121, v18, v19
  buffer_store_dwordx2 v[120:121], v109, s[4:7], s61 offen offset:1024 sc1
  v_add_f32 v20, v20, v76
  v_add_f32 v21, v21, v77
  v_add_f32 v22, v22, v78
  v_add_f32 v23, v23, v79
  v_and_b32 v112, 0xffff0000, v87
  v_lshlrev_b32 v113, 16, v87
  v_and_b32 v114, 0xffff0000, v86
  v_lshlrev_b32 v115, 16, v86
  v_fma_f32 v20, v112, s60, v20
  v_fma_f32 v21, v113, s60, v21
  v_fma_f32 v22, v114, s60, v22
  v_fma_f32 v23, v115, s60, v23
  v_cvt_pk_bf16_f32 v122, v20, v21
  v_cvt_pk_bf16_f32 v123, v22, v23
  buffer_store_dwordx2 v[122:123], v109, s[4:7], s61 offen offset:1536 sc1
  s_branch L_toload_45
L_auxend_4:
  s_sub_u32 s58, s3, 8
  s_barrier
  s_waitcnt lgkmcnt(0)
  s_mov_b32 s4, s86
  s_mov_b32 s5, s87
  s_mov_b32 s6, 14680064
  s_mov_b32 s7, 0x00020000
  v_mov_b32 v154, 13647872
  buffer_load_dword v154, v154, s[4:7], 0 offen sc1
  s_waitcnt vmcnt(0)
  v_readfirstlane_b32 s63, v154
  s_nop 3
  s_mul_i32 s93, s63, 0x9E3779B1
  s_add_u32 s93, s93, 0x7F4A7C15
L_toload_45:
  s_waitcnt lgkmcnt(0)
  s_mov_b32 s40, s80
  s_mov_b32 s41, s81
  s_mov_b32 s42, 401408
  s_mov_b32 s43, 0x00020000
  s_and_b32 s52, s2, 7
  s_lshr_b32 s53, s2, 3
  s_and_b32 s54, s53, 1
  s_lshl_b32 s52, s52, 1
  s_add_u32 s52, s52, s54
  s_lshr_b32 s53, s53, 1
  s_add_u32 s88, s52, 16
  s_mul_i32 s88, s88, 21846
  s_lshr_b32 s88, s88, 16
  s_add_u32 s89, s52, 32
  s_mul_i32 s89, s89, 21846
  s_lshr_b32 s89, s89, 16
  s_mul_i32 s90, s52, 21846
  s_lshr_b32 s90, s90, 16
  s_lshl_b32 s90, s90, 4
  s_add_u32 s90, s90, s53
  s_lshl_b32 s88, s88, 4
  s_lshl_b32 s89, s89, 4
  v_and_b32 v158, 15, v1
  v_add_u32 v163, s88, v158
  v_add_u32 v164, s89, v158
  v_cmp_lt_u32 vcc, 15, v1
  v_mov_b32 v165, s90
  s_nop 0
  v_cndmask_b32 v158, v163, v164, vcc
  v_cmp_lt_u32 vcc, 31, v1
  s_nop 1
  v_cndmask_b32 v158, v158, v165, vcc
  v_lshlrev_b32 v158, 4, v158
  v_add_u32 v158, 13635584, v158
  v_lshlrev_b32 v4, 4, v1
  s_lshl_b32 s63, s58, 12
  s_lshl_b32 s57, s52, 18
  s_add_u32 s57, s57, s63
  s_add_u32 s57, s57, 2162688
  s_mov_b32 s56, 0x00300030
  s_mov_b32 s60, 65536
  s_mov_b32 s61, 0
  s_mov_b32 s98, 0
  s_lshr_b32 s88, s2, 3
  s_mul_i32 s89, s88, 9363
  s_lshr_b32 s89, s89, 16
  s_mul_i32 s89, s89, 7
  s_sub_u32 s89, s88, s89
  v_and_b32 v5, 7, v1
  v_bfe_u32 v6, v1, 4, 1
  v_lshlrev_b32 v6, 2, v6
  v_xor_b32 v5, v5, v6
  v_lshlrev_b32 v5, 4, v5
  v_lshrrev_b32 v6, 3, v1
  v_mul_u32_u24 v6, 896, v6
  v_add_u32 v7, v5, v6
  s_mul_i32 s62, s58, 7168
  s_lshl_b32 s89, s89, 7
  s_add_u32 s62, s62, s89
  s_lshl_b32 s99, s58, 10
  s_add_u32 s99, s99, 98304
  s_mov_b32 s55, s58
  buffer_load_dword v159, v158, s[4:7], 0 offen sc1
L_ldloop_46:
  s_cmp_eq_u32 s98, 0
  s_cbranch_scc1 L_vm0_48
  s_waitcnt vmcnt(3)
  s_branch L_vm1_49
L_vm0_48:
  s_waitcnt vmcnt(0)
L_vm1_49:
  s_barrier
  s_or_b32 s88, s61, s58
  s_cmp_lg_u32 s88, 0
  s_cbranch_scc1 L_sigC_52
  s_cmp_ge_u32 s13, 224
  s_cbranch_scc1 L_sigC_52
  s_lshl_b32 s94, s13, 4
  s_add_u32 s94, s94, 13639680
  v_mov_b32 v160, s93
  v_mov_b32 v161, 0
  s_mov_b64 exec, 1
  buffer_store_dword v160, v161, s[4:7], s94 offen sc1
  s_mov_b64 exec, -1
L_sigC_52:
  s_cmp_ge_u32 s61, 6
  s_cbranch_scc1 L_ldexit_47
  v_cmp_ne_u32 vcc, s93, v159
  s_mov_b32 s96, s56
  s_mov_b32 s97, 0
  s_and_b64 vcc, vcc, s[96:97]
  s_cbranch_vccz L_kvok_50
  s_mov_b32 s94, 0
L_pollm_53:
  buffer_load_dword v162, v158, s[4:7], 0 offen sc1
  s_add_u32 s94, s94, 1
  s_waitcnt vmcnt(0)
  v_cmp_ne_u32 vcc, s93, v162
  s_cmp_gt_u32 s94, 65536
  s_cbranch_scc1 L_pollmx_54
  s_and_b64 vcc, vcc, s[96:97]
  s_cbranch_vccz L_pollmx_54
  s_sleep 1
  s_branch L_pollm_53
L_pollmx_54:
L_kvok_50:
  s_lshl_b32 s56, s56, 2
  s_add_u32 s88, s60, s63
  s_add_u32 m0, s88, 0
  s_add_u32 s89, s57, 0
  buffer_load_dwordx4 v4, s[4:7], s89 offen offset:0 sc1 lds
  buffer_load_dwordx4 v4, s[4:7], s89 offen offset:1024 sc1 lds
  buffer_load_dwordx4 v4, s[4:7], s89 offen offset:2048 sc1 lds
  buffer_load_dwordx4 v4, s[4:7], s89 offen offset:3072 sc1 lds
  s_add_u32 s88, s60, s63
  s_add_u32 m0, s88, 16384
  s_add_u32 s89, s57, 16384
  buffer_load_dwordx4 v4, s[4:7], s89 offen offset:0 sc1 lds
  buffer_load_dwordx4 v4, s[4:7], s89 offen offset:1024 sc1 lds
  buffer_load_dwordx4 v4, s[4:7], s89 offen offset:2048 sc1 lds
  buffer_load_dwordx4 v4, s[4:7], s89 offen offset:3072 sc1 lds
  buffer_load_dword v159, v158, s[4:7], 0 offen sc1
  s_mov_b32 s98, 0
  s_cmp_ge_u32 s2, 224
  s_cbranch_scc1 L_nowo_51
  s_cmp_ge_u32 s61, 5
  s_cbranch_scc1 L_nowo_51
  s_cmp_gt_u32 s55, 56
  s_cbranch_scc1 L_wop_55
  s_mov_b32 m0, s99
  s_nop 0
  buffer_load_dwordx4 v7, s[40:43], s62 offen lds
L_wop_55:
  s_add_u32 s99, s99, 4096
  s_add_u32 s62, s62, 28672
  s_add_u32 s55, s55, 4
  s_cmp_gt_u32 s55, 56
  s_cbranch_scc1 L_wop_56
  s_mov_b32 m0, s99
  s_nop 0
  buffer_load_dwordx4 v7, s[40:43], s62 offen lds
L_wop_56:
  s_add_u32 s99, s99, 4096
  s_add_u32 s62, s62, 28672
  s_add_u32 s55, s55, 4
  s_cmp_gt_u32 s55, 56
  s_cbranch_scc1 L_wop_57
  s_mov_b32 m0, s99
  s_nop 0
  buffer_load_dwordx4 v7, s[40:43], s62 offen lds
L_wop_57:
  s_add_u32 s99, s99, 4096
  s_add_u32 s62, s62, 28672
  s_add_u32 s55, s55, 4
  s_cmp_lt_u32 s61, 4
  s_cselect_b32 s98, 1, 0
L_nowo_51:
  s_add_u32 s57, s57, 32768
  s_add_u32 s60, s60, 32768
  s_cmp_eq_u32 s60, 98304
  s_cselect_b32 s60, 0, s60
  s_add_u32 s61, s61, 1
  s_branch L_ldloop_46
L_ldexit_47:
  s_endpgm
L_helpw_8:
  s_sub_u32 s58, s3, 4
  v_lshrrev_b32 v50, 3, v1
  v_mul_u32_u24 v50, 896, v50
  v_and_b32 v51, 7, v1
  v_lshrrev_b32 v52, 4, v1
  v_xor_b32 v51, v51, v52
  v_xor_b32 v52, 4, v51
  v_lshl_add_u32 v51, v51, 4, v50
  v_lshl_add_u32 v52, v52, 4, v50
  v_add_u32 v53, 0, v1
  v_mul_u32_u24 v54, 5462, v53
  v_lshrrev_b32 v54, 16, v54
  v_mul_u32_u24 v55, 12, v54
  v_sub_u32 v55, v53, v55
  v_mul_u32_u24 v54, 2688, v54
  v_lshl_add_u32 v56, v55, 4, v54
  v_add_u32 v53, 64, v1
  v_mul_u32_u24 v54, 5462, v53
  v_lshrrev_b32 v54, 16, v54
  v_mul_u32_u24 v55, 12, v54
  v_sub_u32 v55, v53, v55
  v_mul_u32_u24 v54, 2688, v54
  v_lshl_add_u32 v57, v55, 4, v54
  v_add_u32 v53, 128, v1
  v_mul_u32_u24 v54, 5462, v53
  v_lshrrev_b32 v54, 16, v54
  v_mul_u32_u24 v55, 12, v54
  v_sub_u32 v55, v53, v55
  v_mul_u32_u24 v54, 2688, v54
  v_lshl_add_u32 v58, v55, 4, v54
  s_lshl_b32 s60, s54, 7
  s_lshl_b32 s61, s58, 5
  s_add_u32 s60, s60, s61
  s_mul_i32 s60, s60, 896
  s_mul_i32 s61, s58, 43008
  s_mul_i32 s62, s55, 168
  s_add_u32 s61, s61, s62
  s_lshl_b32 s62, s58, 12
  s_mul_i32 s59, s58, 3072
  s_lshr_b32 s95, s53, 2
  s_and_b32 s92, s53, 3
  s_lshl_b32 s92, s92, 1
  s_add_u32 s95, s95, s92
  s_cmp_ge_u32 s95, 7
  s_cselect_b32 s92, 7, 0
  s_sub_u32 s99, s95, s92
  s_mov_b32 s57, s99
  s_waitcnt lgkmcnt(0)
  s_mov_b32 s8, s76
  s_mov_b32 s9, s77
  s_mov_b32 s10, 1835008
  s_mov_b32 s11, 0x00020000
  s_mov_b32 s12, s78
  s_mov_b32 s13, s79
  s_mov_b32 s14, 1204224
  s_mov_b32 s15, 0x00020000
  s_lshl_b32 s98, s99, 7
  s_add_u32 s98, s98, s60
  s_add_u32 m0, s62, 0
  s_add_u32 s92, s98, 0
  buffer_load_dwordx4 v51, s[8:11], s92 offen lds
  s_add_u32 m0, s62, 1024
  s_add_u32 s92, s98, 7168
  buffer_load_dwordx4 v52, s[8:11], s92 offen lds
  s_add_u32 m0, s62, 2048
  s_add_u32 s92, s98, 14336
  buffer_load_dwordx4 v51, s[8:11], s92 offen lds
  s_add_u32 m0, s62, 3072
  s_add_u32 s92, s98, 21504
  buffer_load_dwordx4 v52, s[8:11], s92 offen lds
  s_add_u32 s99, s99, 1
  s_cmp_eq_u32 s99, 7
  s_cselect_b32 s99, 0, s99
  s_barrier
  s_mul_i32 s92, s57, 172032
  s_add_u32 s92, s92, s61
  s_add_u32 m0, s59, 16384
  s_nop 0
  buffer_load_dwordx4 v56, s[12:15], s92 offen lds
  s_add_u32 m0, s59, 17408
  s_nop 0
  buffer_load_dwordx4 v57, s[12:15], s92 offen lds
  s_add_u32 m0, s59, 18432
  s_nop 0
  buffer_load_dwordx4 v58, s[12:15], s92 offen lds
  s_add_u32 s57, s57, 1
  s_cmp_eq_u32 s57, 7
  s_cselect_b32 s57, 0, s57
  s_lshl_b32 s98, s99, 7
  s_add_u32 s98, s98, s60
  s_add_u32 m0, s62, 28672
  s_add_u32 s92, s98, 0
  buffer_load_dwordx4 v51, s[8:11], s92 offen lds
  s_add_u32 m0, s62, 29696
  s_add_u32 s92, s98, 7168
  buffer_load_dwordx4 v52, s[8:11], s92 offen lds
  s_add_u32 m0, s62, 30720
  s_add_u32 s92, s98, 14336
  buffer_load_dwordx4 v51, s[8:11], s92 offen lds
  s_add_u32 m0, s62, 31744
  s_add_u32 s92, s98, 21504
  buffer_load_dwordx4 v52, s[8:11], s92 offen lds
  s_add_u32 s99, s99, 1
  s_cmp_eq_u32 s99, 7
  s_cselect_b32 s99, 0, s99
  s_waitcnt vmcnt(4)
  v_mov_b32 v160, 157232
  v_mov_b32 v161, 1
  s_mov_b64 exec, 1
  ds_add_u32 v160, v161
  s_mov_b64 exec, -1
  s_mul_i32 s92, s57, 172032
  s_add_u32 s92, s92, s61
  s_add_u32 m0, s59, 45056
  s_nop 0
  buffer_load_dwordx4 v56, s[12:15], s92 offen lds
  s_add_u32 m0, s59, 46080
  s_nop 0
  buffer_load_dwordx4 v57, s[12:15], s92 offen lds
  s_add_u32 m0, s59, 47104
  s_nop 0
  buffer_load_dwordx4 v58, s[12:15], s92 offen lds
  s_add_u32 s57, s57, 1
  s_cmp_eq_u32 s57, 7
  s_cselect_b32 s57, 0, s57
  s_lshl_b32 s98, s99, 7
  s_add_u32 s98, s98, s60
  s_add_u32 m0, s62, 57344
  s_add_u32 s92, s98, 0
  buffer_load_dwordx4 v51, s[8:11], s92 offen lds
  s_add_u32 m0, s62, 58368
  s_add_u32 s92, s98, 7168
  buffer_load_dwordx4 v52, s[8:11], s92 offen lds
  s_add_u32 m0, s62, 59392
  s_add_u32 s92, s98, 14336
  buffer_load_dwordx4 v51, s[8:11], s92 offen lds
  s_add_u32 m0, s62, 60416
  s_add_u32 s92, s98, 21504
  buffer_load_dwordx4 v52, s[8:11], s92 offen lds
  s_add_u32 s99, s99, 1
  s_cmp_eq_u32 s99, 7
  s_cselect_b32 s99, 0, s99
  s_mul_i32 s92, s57, 172032
  s_add_u32 s92, s92, s61
  s_add_u32 m0, s59, 73728
  s_nop 0
  buffer_load_dwordx4 v56, s[12:15], s92 offen lds
  s_add_u32 m0, s59, 74752
  s_nop 0
  buffer_load_dwordx4 v57, s[12:15], s92 offen lds
  s_add_u32 m0, s59, 75776
  s_nop 0
  buffer_load_dwordx4 v58, s[12:15], s92 offen lds
  s_add_u32 s57, s57, 1
  s_cmp_eq_u32 s57, 7
  s_cselect_b32 s57, 0, s57
  s_waitcnt vmcnt(7)
  v_mov_b32 v160, 157236
  v_mov_b32 v161, 1
  s_mov_b64 exec, 1
  ds_add_u32 v160, v161
  s_mov_b64 exec, -1
  s_movk_i32 s95, 20
  s_lshl_b32 s94, s95, 2
  s_add_u32 s94, s94, 157184
  v_mov_b32 v160, s94
  s_mov_b32 s96, 0
L_ls_58:
  ds_read_b32 v161, v160
  s_add_u32 s96, s96, 1
  s_waitcnt lgkmcnt(0)
  v_readfirstlane_b32 s94, v161
  s_cmp_gt_u32 s96, 1048576
  s_cbranch_scc1 L_lsx_59
  s_cmp_ge_u32 s94, 4
  s_cbranch_scc1 L_lsx_59
  s_sleep 1
  s_branch L_ls_58
L_lsx_59:
  s_lshl_b32 s98, s99, 7
  s_add_u32 s98, s98, s60
  s_add_u32 m0, s62, 0
  s_add_u32 s92, s98, 0
  buffer_load_dwordx4 v51, s[8:11], s92 offen lds
  s_add_u32 m0, s62, 1024
  s_add_u32 s92, s98, 7168
  buffer_load_dwordx4 v52, s[8:11], s92 offen lds
  s_add_u32 m0, s62, 2048
  s_add_u32 s92, s98, 14336
  buffer_load_dwordx4 v51, s[8:11], s92 offen lds
  s_add_u32 m0, s62, 3072
  s_add_u32 s92, s98, 21504
  buffer_load_dwordx4 v52, s[8:11], s92 offen lds
  s_add_u32 s99, s99, 1
  s_cmp_eq_u32 s99, 7
  s_cselect_b32 s99, 0, s99
  s_mul_i32 s92, s57, 172032
  s_add_u32 s92, s92, s61
  s_add_u32 m0, s59, 16384
  s_nop 0
  buffer_load_dwordx4 v56, s[12:15], s92 offen lds
  s_add_u32 m0, s59, 17408
  s_nop 0
  buffer_load_dwordx4 v57, s[12:15], s92 offen lds
  s_add_u32 m0, s59, 18432
  s_nop 0
  buffer_load_dwordx4 v58, s[12:15], s92 offen lds
  s_add_u32 s57, s57, 1
  s_cmp_eq_u32 s57, 7
  s_cselect_b32 s57, 0, s57
  s_waitcnt vmcnt(7)
  v_mov_b32 v160, 157240
  v_mov_b32 v161, 1
  s_mov_b64 exec, 1
  ds_add_u32 v160, v161
  s_mov_b64 exec, -1
  s_movk_i32 s95, 21
  s_lshl_b32 s94, s95, 2
  s_add_u32 s94, s94, 157184
  v_mov_b32 v160, s94
  s_mov_b32 s96, 0
L_ls_60:
  ds_read_b32 v161, v160
  s_add_u32 s96, s96, 1
  s_waitcnt lgkmcnt(0)
  v_readfirstlane_b32 s94, v161
  s_cmp_gt_u32 s96, 1048576
  s_cbranch_scc1 L_lsx_61
  s_cmp_ge_u32 s94, 4
  s_cbranch_scc1 L_lsx_61
  s_sleep 1
  s_branch L_ls_60
L_lsx_61:
  s_lshl_b32 s98, s99, 7
  s_add_u32 s98, s98, s60
  s_add_u32 m0, s62, 28672
  s_add_u32 s92, s98, 0
  buffer_load_dwordx4 v51, s[8:11], s92 offen lds
  s_add_u32 m0, s62, 29696
  s_add_u32 s92, s98, 7168
  buffer_load_dwordx4 v52, s[8:11], s92 offen lds
  s_add_u32 m0, s62, 30720
  s_add_u32 s92, s98, 14336
  buffer_load_dwordx4 v51, s[8:11], s92 offen lds
  s_add_u32 m0, s62, 31744
  s_add_u32 s92, s98, 21504
  buffer_load_dwordx4 v52, s[8:11], s92 offen lds
  s_add_u32 s99, s99, 1
  s_cmp_eq_u32 s99, 7
  s_cselect_b32 s99, 0, s99
  s_mul_i32 s92, s57, 172032
  s_add_u32 s92, s92, s61
  s_add_u32 m0, s59, 45056
  s_nop 0
  buffer_load_dwordx4 v56, s[12:15], s92 offen lds
  s_add_u32 m0, s59, 46080
  s_nop 0
  buffer_load_dwordx4 v57, s[12:15], s92 offen lds
  s_add_u32 m0, s59, 47104
  s_nop 0
  buffer_load_dwordx4 v58, s[12:15], s92 offen lds
  s_add_u32 s57, s57, 1
  s_cmp_eq_u32 s57, 7
  s_cselect_b32 s57, 0, s57
  s_waitcnt vmcnt(7)
  v_mov_b32 v160, 157244
  v_mov_b32 v161, 1
  s_mov_b64 exec, 1
  ds_add_u32 v160, v161
  s_mov_b64 exec, -1
  s_movk_i32 s95, 22
  s_lshl_b32 s94, s95, 2
  s_add_u32 s94, s94, 157184
  v_mov_b32 v160, s94
  s_mov_b32 s96, 0
L_ls_62:
  ds_read_b32 v161, v160
  s_add_u32 s96, s96, 1
  s_waitcnt lgkmcnt(0)
  v_readfirstlane_b32 s94, v161
  s_cmp_gt_u32 s96, 1048576
  s_cbranch_scc1 L_lsx_63
  s_cmp_ge_u32 s94, 4
  s_cbranch_scc1 L_lsx_63
  s_sleep 1
  s_branch L_ls_62
L_lsx_63:
  s_lshl_b32 s98, s99, 7
  s_add_u32 s98, s98, s60
  s_add_u32 m0, s62, 57344
  s_add_u32 s92, s98, 0
  buffer_load_dwordx4 v51, s[8:11], s92 offen lds
  s_add_u32 m0, s62, 58368
  s_add_u32 s92, s98, 7168
  buffer_load_dwordx4 v52, s[8:11], s92 offen lds
  s_add_u32 m0, s62, 59392
  s_add_u32 s92, s98, 14336
  buffer_load_dwordx4 v51, s[8:11], s92 offen lds
  s_add_u32 m0, s62, 60416
  s_add_u32 s92, s98, 21504
  buffer_load_dwordx4 v52, s[8:11], s92 offen lds
  s_add_u32 s99, s99, 1
  s_cmp_eq_u32 s99, 7
  s_cselect_b32 s99, 0, s99
  s_mul_i32 s92, s57, 172032
  s_add_u32 s92, s92, s61
  s_add_u32 m0, s59, 73728
  s_nop 0
  buffer_load_dwordx4 v56, s[12:15], s92 offen lds
  s_add_u32 m0, s59, 74752
  s_nop 0
  buffer_load_dwordx4 v57, s[12:15], s92 offen lds
  s_add_u32 m0, s59, 75776
  s_nop 0
  buffer_load_dwordx4 v58, s[12:15], s92 offen lds
  s_add_u32 s57, s57, 1
  s_cmp_eq_u32 s57, 7
  s_cselect_b32 s57, 0, s57
  s_waitcnt vmcnt(7)
  v_mov_b32 v160, 157248
  v_mov_b32 v161, 1
  s_mov_b64 exec, 1
  ds_add_u32 v160, v161
  s_mov_b64 exec, -1
  s_movk_i32 s95, 23
  s_lshl_b32 s94, s95, 2
  s_add_u32 s94, s94, 157184
  v_mov_b32 v160, s94
  s_mov_b32 s96, 0
L_ls_64:
  ds_read_b32 v161, v160
  s_add_u32 s96, s96, 1
  s_waitcnt lgkmcnt(0)
  v_readfirstlane_b32 s94, v161
  s_cmp_gt_u32 s96, 1048576
  s_cbranch_scc1 L_lsx_65
  s_cmp_ge_u32 s94, 4
  s_cbranch_scc1 L_lsx_65
  s_sleep 1
  s_branch L_ls_64
L_lsx_65:
  s_lshl_b32 s98, s99, 7
  s_add_u32 s98, s98, s60
  s_add_u32 m0, s62, 0
  s_add_u32 s92, s98, 0
  buffer_load_dwordx4 v51, s[8:11], s92 offen lds
  s_add_u32 m0, s62, 1024
  s_add_u32 s92, s98, 7168
  buffer_load_dwordx4 v52, s[8:11], s92 offen lds
  s_add_u32 m0, s62, 2048
  s_add_u32 s92, s98, 14336
  buffer_load_dwordx4 v51, s[8:11], s92 offen lds
  s_add_u32 m0, s62, 3072
  s_add_u32 s92, s98, 21504
  buffer_load_dwordx4 v52, s[8:11], s92 offen lds
  s_add_u32 s99, s99, 1
  s_cmp_eq_u32 s99, 7
  s_cselect_b32 s99, 0, s99
  s_mul_i32 s92, s57, 172032
  s_add_u32 s92, s92, s61
  s_add_u32 m0, s59, 16384
  s_nop 0
  buffer_load_dwordx4 v56, s[12:15], s92 offen lds
  s_add_u32 m0, s59, 17408
  s_nop 0
  buffer_load_dwordx4 v57, s[12:15], s92 offen lds
  s_add_u32 m0, s59, 18432
  s_nop 0
  buffer_load_dwordx4 v58, s[12:15], s92 offen lds
  s_add_u32 s57, s57, 1
  s_cmp_eq_u32 s57, 7
  s_cselect_b32 s57, 0, s57
  s_waitcnt vmcnt(7)
  v_mov_b32 v160, 157252
  v_mov_b32 v161, 1
  s_mov_b64 exec, 1
  ds_add_u32 v160, v161
  s_mov_b64 exec, -1
  s_waitcnt lgkmcnt(0)
  s_mov_b32 s28, s64
  s_mov_b32 s29, s65
  s_mov_b32 s30, 1835008
  s_mov_b32 s31, 0x00020000
  s_mov_b32 s36, s74
  s_mov_b32 s37, s75
  s_mov_b32 s38, 896
  s_mov_b32 s39, 0x00020000
  s_mov_b32 s40, s80
  s_mov_b32 s41, s81
  s_mov_b32 s42, 401408
  s_mov_b32 s43, 0x00020000
  s_mov_b32 s44, s82
  s_mov_b32 s45, s83
  s_mov_b32 s46, 3670016
  s_mov_b32 s47, 0x00020000
  s_mov_b32 s4, s86
  s_mov_b32 s5, s87
  s_mov_b32 s6, 14680064
  s_mov_b32 s7, 0x00020000
  v_mov_b32 v154, 13647872
  buffer_load_dword v154, v154, s[4:7], 0 offen sc1
  s_waitcnt vmcnt(0)
  v_mov_b32 v160, 157256
  v_mov_b32 v161, 1
  s_mov_b64 exec, 1
  ds_add_u32 v160, v161
  s_mov_b64 exec, -1
  s_waitcnt lgkmcnt(0)
  v_readfirstlane_b32 s63, v154
  s_nop 3
  s_mul_i32 s93, s63, 0x9E3779B1
  s_add_u32 s93, s93, 0x7F4A7C15
  s_and_b32 s52, s2, 7
  s_lshr_b32 s53, s2, 3
  s_and_b32 s54, s53, 1
  s_lshl_b32 s52, s52, 1
  s_add_u32 s52, s52, s54
  s_lshr_b32 s53, s53, 1
  s_add_u32 s88, s52, 16
  s_mul_i32 s88, s88, 21846
  s_lshr_b32 s88, s88, 16
  s_add_u32 s89, s52, 32
  s_mul_i32 s89, s89, 21846
  s_lshr_b32 s89, s89, 16
  s_mul_i32 s90, s52, 21846
  s_lshr_b32 s90, s90, 16
  s_lshl_b32 s90, s90, 4
  s_add_u32 s90, s90, s53
  s_lshl_b32 s88, s88, 4
  s_lshl_b32 s89, s89, 4
  v_and_b32 v158, 15, v1
  v_add_u32 v163, s88, v158
  v_add_u32 v164, s89, v158
  v_cmp_lt_u32 vcc, 15, v1
  v_mov_b32 v165, s90
  s_nop 0
  v_cndmask_b32 v158, v163, v164, vcc
  v_cmp_lt_u32 vcc, 31, v1
  s_nop 1
  v_cndmask_b32 v158, v158, v165, vcc
  v_lshlrev_b32 v158, 4, v158
  v_add_u32 v158, 13635584, v158
  s_and_b32 s54, s3, 3
  s_lshr_b32 s55, s3, 2
  v_lshlrev_b32 v4, 4, v1
  s_lshl_b32 s58, s3, 12
  s_lshl_b32 s59, s55, 14
  s_lshl_b32 s92, s53, 2
  s_add_u32 s92, s92, s54
  s_lshl_b32 s92, s92, 4
  s_add_u32 s92, s92, s52
  s_lshl_b32 s92, s92, 11
  s_add_u32 s92, s92, 10485760
  s_lshl_b32 s88, s54, 12
  s_add_u32 s88, s88, 81920
  v_add_u32 v157, s88, v4
  v_cmp_gt_u32 vcc, 32, v1
  v_mov_b32 v156, 0
  s_nop 0
  v_cndmask_b32 v156, v156, -1, vcc
  v_mov_b32 v16, 0
  v_mov_b32 v17, 0
  v_mov_b32 v18, 0
  v_mov_b32 v19, 0
  v_mov_b32 v20, 0
  v_mov_b32 v21, 0
  v_mov_b32 v22, 0
  v_mov_b32 v23, 0
  v_mov_b32 v24, 0
  v_mov_b32 v25, 0
  v_mov_b32 v26, 0
  v_mov_b32 v27, 0
  v_mov_b32 v28, 0
  v_mov_b32 v29, 0
  v_mov_b32 v30, 0
  v_mov_b32 v31, 0
  s_mov_b32 s101, 0
  s_lshl_b32 s57, s52, 18
  s_add_u32 s57, s57, s58
  s_add_u32 s57, s57, 2162688
  s_mov_b32 s56, 0x00300030
  v_add_u32 v2, s59, v4
  v_add_u32 v3, 32768, v2
  v_mov_b32 v88, 0
  v_mov_b32 v89, 0
  v_mov_b32 v90, 0
  v_mov_b32 v91, 0
  v_mov_b32 v92, 0
  v_mov_b32 v93, 0
  v_mov_b32 v94, 0
  v_mov_b32 v95, 0
  v_mov_b32 v96, 0
  v_mov_b32 v97, 0
  v_mov_b32 v98, 0
  v_mov_b32 v99, 0
  v_mov_b32 v100, 0
  v_mov_b32 v101, 0
  v_mov_b32 v102, 0
  v_mov_b32 v103, 0
  v_mov_b32 v68, 0
  v_mov_b32 v69, 0
  v_mov_b32 v70, 0
  v_mov_b32 v71, 0
  s_mov_b32 s60, 65536
  s_mov_b32 s61, 0
  s_mov_b32 s98, 0
  s_cmp_lg_u32 s3, 4
  s_cbranch_scc1 L_bpoll_66
  s_mov_b32 s96, 983055
  s_mov_b32 s97, 1
  s_mov_b32 s94, 0
L_pollm_67:
  buffer_load_dword v162, v158, s[4:7], 0 offen sc1
  s_add_u32 s94, s94, 1
  s_waitcnt vmcnt(0)
  v_cmp_ne_u32 vcc, s93, v162
  s_cmp_gt_u32 s94, 65536
  s_cbranch_scc1 L_pollmx_68
  s_and_b64 vcc, vcc, s[96:97]
  s_cbranch_vccz L_pollmx_68
  s_sleep 1
  s_branch L_pollm_67
L_pollmx_68:
  v_mov_b32 v160, 157200
  v_mov_b32 v161, 1
  s_mov_b64 exec, 1
  ds_add_u32 v160, v161
  s_mov_b64 exec, -1
L_bpoll_66:
  s_movk_i32 s95, 4
  s_lshl_b32 s94, s95, 2
  s_add_u32 s94, s94, 157184
  v_mov_b32 v160, s94
  s_mov_b32 s96, 0
L_ls_69:
  ds_read_b32 v161, v160
  s_add_u32 s96, s96, 1
  s_waitcnt lgkmcnt(0)
  v_readfirstlane_b32 s94, v161
  s_cmp_gt_u32 s96, 1048576
  s_cbranch_scc1 L_lsx_70
  s_cmp_ge_u32 s94, 1
  s_cbranch_scc1 L_lsx_70
  s_sleep 1
  s_branch L_ls_69
L_lsx_70:
  s_branch L_join_1
L_gemmw_2:
  s_waitcnt lgkmcnt(0)
  s_mov_b32 s28, s64
  s_mov_b32 s29, s65
  s_mov_b32 s30, 1835008
  s_mov_b32 s31, 0x00020000
  s_mov_b32 s36, s74
  s_mov_b32 s37, s75
  s_mov_b32 s38, 896
  s_mov_b32 s39, 0x00020000
  s_mov_b32 s40, s80
  s_mov_b32 s41, s81
  s_mov_b32 s42, 401408
  s_mov_b32 s43, 0x00020000
  s_mov_b32 s44, s82
  s_mov_b32 s45, s83
  s_mov_b32 s46, 3670016
  s_mov_b32 s47, 0x00020000
  s_mov_b32 s4, s86
  s_mov_b32 s5, s87
  s_mov_b32 s6, 14680064
  s_mov_b32 s7, 0x00020000
  v_mov_b32 v154, 13647872
  buffer_load_dword v154, v154, s[4:7], 0 offen sc1
  v_and_b32 v2, 31, v1
  v_lshrrev_b32 v3, 5, v1
  v_bfe_u32 v4, v2, 1, 3
  s_lshl_b32 s58, s3, 12
  v_lshlrev_b32 v5, 7, v2
  v_add_u32 v5, s58, v5
  v_add_u32 v6, 0, v3
  v_xor_b32 v6, v6, v4
  v_lshl_add_u32 v40, v6, 4, v5
  v_add_u32 v6, 2, v3
  v_xor_b32 v6, v6, v4
  v_lshl_add_u32 v41, v6, 4, v5
  v_add_u32 v6, 4, v3
  v_xor_b32 v6, v6, v4
  v_lshl_add_u32 v42, v6, 4, v5
  v_add_u32 v6, 6, v3
  v_xor_b32 v6, v6, v4
  v_lshl_add_u32 v43, v6, 4, v5
  v_bfe_u32 v6, v1, 2, 2
  v_lshl_add_u32 v6, v3, 3, v6
  v_mul_u32_u24 v6, 192, v6
  v_bfe_u32 v7, v1, 4, 1
  v_lshl_add_u32 v6, v7, 5, v6
  v_and_b32 v7, 3, v1
  v_lshl_add_u32 v6, v7, 3, v6
  v_add_u32 v44, 16384, v6
  v_mov_b32 v64, 0
  v_mov_b32 v65, 0
  v_mov_b32 v66, 0
  v_mov_b32 v67, 0
  v_mov_b32 v68, 0
  v_mov_b32 v69, 0
  v_mov_b32 v70, 0
  v_mov_b32 v71, 0
  v_mov_b32 v72, 0
  v_mov_b32 v73, 0
  v_mov_b32 v74, 0
  v_mov_b32 v75, 0
  v_mov_b32 v76, 0
  v_mov_b32 v77, 0
  v_mov_b32 v78, 0
  v_mov_b32 v79, 0
  v_mov_b32 v80, 0
  v_mov_b32 v81, 0
  v_mov_b32 v82, 0
  v_mov_b32 v83, 0
  v_mov_b32 v84, 0
  v_mov_b32 v85, 0
  v_mov_b32 v86, 0
  v_mov_b32 v87, 0
  v_mov_b32 v88, 0
  v_mov_b32 v89, 0
  v_mov_b32 v90, 0
  v_mov_b32 v91, 0
  v_mov_b32 v92, 0
  v_mov_b32 v93, 0
  v_mov_b32 v94, 0
  v_mov_b32 v95, 0
  v_mov_b32 v96, 0
  v_mov_b32 v97, 0
  v_mov_b32 v98, 0
  v_mov_b32 v99, 0
  v_mov_b32 v100, 0
  v_mov_b32 v101, 0
  v_mov_b32 v102, 0
  v_mov_b32 v103, 0
  v_mov_b32 v104, 0
  v_mov_b32 v105, 0
  v_mov_b32 v106, 0
  v_mov_b32 v107, 0
  v_mov_b32 v108, 0
  v_mov_b32 v109, 0
  v_mov_b32 v110, 0
  v_mov_b32 v111, 0
  s_lshl_b32 s58, s54, 2
  s_add_u32 s58, s58, s3
  s_mul_i32 s88, s55, 3
  s_add_u32 s88, s88, 0
  s_lshr_b32 s89, s88, 4
  s_and_b32 s88, s88, 15
  s_lshl_b32 s88, s88, 6
  s_add_u32 s88, s88, s58
  s_cmp_eq_u32 s89, 0
  s_cselect_b32 s90, 11, 12
  s_cselect_b32 s91, 0, 2097152
  s_lshl_b32 s88, s88, s90
  s_add_u32 s88, s88, s91
  s_cmp_eq_u32 s89, 2
  s_cselect_b32 s90, 2048, 0
  s_add_u32 s60, s88, s90
  s_mul_i32 s88, s55, 3
  s_add_u32 s88, s88, 1
  s_lshr_b32 s89, s88, 4
  s_and_b32 s88, s88, 15
  s_lshl_b32 s88, s88, 6
  s_add_u32 s88, s88, s58
  s_cmp_eq_u32 s89, 0
  s_cselect_b32 s90, 11, 12
  s_cselect_b32 s91, 0, 2097152
  s_lshl_b32 s88, s88, s90
  s_add_u32 s88, s88, s91
  s_cmp_eq_u32 s89, 2
  s_cselect_b32 s90, 2048, 0
  s_add_u32 s61, s88, s90
  s_mul_i32 s88, s55, 3
  s_add_u32 s88, s88, 2
  s_lshr_b32 s89, s88, 4
  s_and_b32 s88, s88, 15
  s_lshl_b32 s88, s88, 6
  s_add_u32 s88, s88, s58
  s_cmp_eq_u32 s89, 0
  s_cselect_b32 s90, 11, 12
  s_cselect_b32 s91, 0, 2097152
  s_lshl_b32 s88, s88, s90
  s_add_u32 s88, s88, s91
  s_cmp_eq_u32 s89, 2
  s_cselect_b32 s90, 2048, 0
  s_add_u32 s62, s88, s90
  v_lshlrev_b32 v50, 4, v1
  v_cmp_gt_u32 vcc, 32, v1
  v_mov_b32 v51, 0
  v_and_b32 v54, 31, v1
  v_cndmask_b32 v51, v51, -1, vcc
  v_cmp_gt_u32 vcc, 28, v54
  v_mov_b32 v52, 0
  v_mov_b32 v53, 0
  v_cndmask_b32 v52, v52, -1, vcc
  v_cmp_eq_u32 vcc, 28, v54
  v_mov_b32 v55, 0x3f803f80
  s_nop 0
  v_cndmask_b32 v53, v53, v55, vcc
  s_waitcnt vmcnt(0)
  v_readfirstlane_b32 s63, v154
  s_nop 3
  s_mul_i32 s93, s63, 0x9E3779B1
  s_add_u32 s93, s93, 0x7F4A7C15
  s_cmp_ge_u32 s55, 11
  s_cbranch_scc1 L_gv2_73
  s_cmp_eq_u32 s55, 10
  s_cbranch_scc1 L_gv1_72
L_gv0_71:
  s_mov_b32 s59, 0
  s_mov_b32 s57, 0
L_gchunk_75:
  s_add_u32 s95, s59, 12
  s_lshl_b32 s94, s95, 2
  s_add_u32 s94, s94, 157184
  v_mov_b32 v160, s94
  s_mov_b32 s96, 0
L_ls_76:
  ds_read_b32 v161, v160
  s_add_u32 s96, s96, 1
  s_waitcnt lgkmcnt(0)
  v_readfirstlane_b32 s94, v161
  s_cmp_gt_u32 s96, 1048576
  s_cbranch_scc1 L_lsx_77
  s_cmp_ge_u32 s94, 4
  s_cbranch_scc1 L_lsx_77
  s_sleep 1
  s_branch L_ls_76
L_lsx_77:
  ds_read_b128 v[8:11], v40
  ds_read_b64_tr_b16 v[16:17], v44 offset:0
  ds_read_b64_tr_b16 v[18:19], v44 offset:768
  ds_read_b64_tr_b16 v[20:21], v44 offset:56
  ds_read_b64_tr_b16 v[22:23], v44 offset:824
  ds_read_b64_tr_b16 v[24:25], v44 offset:112
  ds_read_b64_tr_b16 v[26:27], v44 offset:880
  ds_read_b128 v[12:15], v41
  ds_read_b64_tr_b16 v[28:29], v44 offset:3072
  ds_read_b64_tr_b16 v[30:31], v44 offset:3840
  ds_read_b64_tr_b16 v[32:33], v44 offset:3128
  ds_read_b64_tr_b16 v[34:35], v44 offset:3896
  ds_read_b64_tr_b16 v[36:37], v44 offset:3184
  ds_read_b64_tr_b16 v[38:39], v44 offset:3952
  s_waitcnt lgkmcnt(7)
  v_mfma_f32_32x32x16_bf16 v[64:79], v[16:19], v[8:11], v[64:79]
  v_mfma_f32_32x32x16_bf16 v[80:95], v[20:23], v[8:11], v[80:95]
  v_mfma_f32_32x32x16_bf16 v[96:111], v[24:27], v[8:11], v[96:111]
  ds_read_b128 v[8:11], v42
  ds_read_b64_tr_b16 v[16:17], v44 offset:6144
  ds_read_b64_tr_b16 v[18:19], v44 offset:6912
  ds_read_b64_tr_b16 v[20:21], v44 offset:6200
  ds_read_b64_tr_b16 v[22:23], v44 offset:6968
  ds_read_b64_tr_b16 v[24:25], v44 offset:6256
  ds_read_b64_tr_b16 v[26:27], v44 offset:7024
  s_waitcnt lgkmcnt(7)
  v_mfma_f32_32x32x16_bf16 v[64:79], v[28:31], v[12:15], v[64:79]
  v_mfma_f32_32x32x16_bf16 v[80:95], v[32:35], v[12:15], v[80:95]
  v_mfma_f32_32x32x16_bf16 v[96:111], v[36:39], v[12:15], v[96:111]
  ds_read_b128 v[12:15], v43
  ds_read_b64_tr_b16 v[28:29], v44 offset:9216
  ds_read_b64_tr_b16 v[30:31], v44 offset:9984
  ds_read_b64_tr_b16 v[32:33], v44 offset:9272
  ds_read_b64_tr_b16 v[34:35], v44 offset:10040
  ds_read_b64_tr_b16 v[36:37], v44 offset:9328
  ds_read_b64_tr_b16 v[38:39], v44 offset:10096
  s_waitcnt lgkmcnt(7)
  v_mfma_f32_32x32x16_bf16 v[64:79], v[16:19], v[8:11], v[64:79]
  v_mfma_f32_32x32x16_bf16 v[80:95], v[20:23], v[8:11], v[80:95]
  v_mfma_f32_32x32x16_bf16 v[96:111], v[24:27], v[8:11], v[96:111]
  s_waitcnt lgkmcnt(0)
  s_cmp_eq_u32 s59, 6
  s_cselect_b32 s95, 4, s59
  s_cmp_gt_u32 s95, 4
  s_cbranch_scc1 L_nodn_78
  s_cmp_eq_u32 s59, 4
  s_cbranch_scc1 L_nodn_78
  s_add_u32 s95, s95, 20
  s_lshl_b32 s94, s95, 2
  s_add_u32 s94, s94, 157184
  v_mov_b32 v160, s94
  v_mov_b32 v161, 1
  s_mov_b64 exec, 1
  ds_add_u32 v160, v161
  s_mov_b64 exec, -1
L_nodn_78:
  v_mfma_f32_32x32x16_bf16 v[64:79], v[28:31], v[12:15], v[64:79]
  v_mfma_f32_32x32x16_bf16 v[80:95], v[32:35], v[12:15], v[80:95]
  v_mfma_f32_32x32x16_bf16 v[96:111], v[36:39], v[12:15], v[96:111]
  s_add_u32 s57, s57, 1
  s_cmp_eq_u32 s57, 3
  s_movk_i32 s88, 28672
  s_cbranch_scc0 L_nowrap_79
  s_mov_b32 s57, 0
  s_mov_b32 s88, 0xffff2000
L_nowrap_79:
  v_add_u32 v40, s88, v40
  v_add_u32 v41, s88, v41
  v_add_u32 v42, s88, v42
  v_add_u32 v43, s88, v43
  v_add_u32 v44, s88, v44
  s_add_u32 s59, s59, 1
  s_cmp_lt_u32 s59, 7
  s_cbranch_scc1 L_gchunk_75
  s_nop 10
  s_mul_i32 s88, s55, 3
  s_add_u32 s88, s88, 0
  s_cmp_ge_u32 s88, 16
  s_cbranch_scc1 L_nosc_80
  s_mov_b32 s88, 0x3e8b97f6
  v_mul_f32 v64, s88, v64
  v_mul_f32 v65, s88, v65
  v_mul_f32 v66, s88, v66
  v_mul_f32 v67, s88, v67
  v_mul_f32 v68, s88, v68
  v_mul_f32 v69, s88, v69
  v_mul_f32 v70, s88, v70
  v_mul_f32 v71, s88, v71
  v_mul_f32 v72, s88, v72
  v_mul_f32 v73, s88, v73
  v_mul_f32 v74, s88, v74
  v_mul_f32 v75, s88, v75
  v_mul_f32 v76, s88, v76
  v_mul_f32 v77, s88, v77
  v_mul_f32 v78, s88, v78
  v_mul_f32 v79, s88, v79
L_nosc_80:
  v_cvt_pk_bf16_f32 v8, v64, v65
  v_cvt_pk_bf16_f32 v9, v66, v67
  v_cvt_pk_bf16_f32 v10, v68, v69
  v_cvt_pk_bf16_f32 v11, v70, v71
  v_cvt_pk_bf16_f32 v12, v72, v73
  v_cvt_pk_bf16_f32 v13, v74, v75
  v_cvt_pk_bf16_f32 v14, v76, v77
  v_cvt_pk_bf16_f32 v15, v78, v79
  v_and_b32 v14, v14, v51
  v_and_b32 v15, v15, v51
  buffer_store_dwordx4 v[8:11], v50, s[4:7], s60 offen sc1
  buffer_store_dwordx4 v[12:15], v50, s[4:7], s60 offen offset:1024 sc1
  s_mul_i32 s88, s55, 3
  s_add_u32 s88, s88, 1
  s_cmp_ge_u32 s88, 16
  s_cbranch_scc1 L_nosc_81
  s_mov_b32 s88, 0x3e8b97f6
  v_mul_f32 v80, s88, v80
  v_mul_f32 v81, s88, v81
  v_mul_f32 v82, s88, v82
  v_mul_f32 v83, s88, v83
  v_mul_f32 v84, s88, v84
  v_mul_f32 v85, s88, v85
  v_mul_f32 v86, s88, v86
  v_mul_f32 v87, s88, v87
  v_mul_f32 v88, s88, v88
  v_mul_f32 v89, s88, v89
  v_mul_f32 v90, s88, v90
  v_mul_f32 v91, s88, v91
  v_mul_f32 v92, s88, v92
  v_mul_f32 v93, s88, v93
  v_mul_f32 v94, s88, v94
  v_mul_f32 v95, s88, v95
L_nosc_81:
  v_cvt_pk_bf16_f32 v16, v80, v81
  v_cvt_pk_bf16_f32 v17, v82, v83
  v_cvt_pk_bf16_f32 v18, v84, v85
  v_cvt_pk_bf16_f32 v19, v86, v87
  v_cvt_pk_bf16_f32 v20, v88, v89
  v_cvt_pk_bf16_f32 v21, v90, v91
  v_cvt_pk_bf16_f32 v22, v92, v93
  v_cvt_pk_bf16_f32 v23, v94, v95
  v_and_b32 v22, v22, v51
  v_and_b32 v23, v23, v51
  buffer_store_dwordx4 v[16:19], v50, s[4:7], s61 offen sc1
  buffer_store_dwordx4 v[20:23], v50, s[4:7], s61 offen offset:1024 sc1
  s_mul_i32 s88, s55, 3
  s_add_u32 s88, s88, 2
  s_cmp_ge_u32 s88, 16
  s_cbranch_scc1 L_nosc_82
  s_mov_b32 s88, 0x3e8b97f6
  v_mul_f32 v96, s88, v96
  v_mul_f32 v97, s88, v97
  v_mul_f32 v98, s88, v98
  v_mul_f32 v99, s88, v99
  v_mul_f32 v100, s88, v100
  v_mul_f32 v101, s88, v101
  v_mul_f32 v102, s88, v102
  v_mul_f32 v103, s88, v103
  v_mul_f32 v104, s88, v104
  v_mul_f32 v105, s88, v105
  v_mul_f32 v106, s88, v106
  v_mul_f32 v107, s88, v107
  v_mul_f32 v108, s88, v108
  v_mul_f32 v109, s88, v109
  v_mul_f32 v110, s88, v110
  v_mul_f32 v111, s88, v111
L_nosc_82:
  v_cvt_pk_bf16_f32 v24, v96, v97
  v_cvt_pk_bf16_f32 v25, v98, v99
  v_cvt_pk_bf16_f32 v26, v100, v101
  v_cvt_pk_bf16_f32 v27, v102, v103
  v_cvt_pk_bf16_f32 v28, v104, v105
  v_cvt_pk_bf16_f32 v29, v106, v107
  v_cvt_pk_bf16_f32 v30, v108, v109
  v_cvt_pk_bf16_f32 v31, v110, v111
  v_and_b32 v30, v30, v51
  v_and_b32 v31, v31, v51
  buffer_store_dwordx4 v[24:27], v50, s[4:7], s62 offen sc1
  buffer_store_dwordx4 v[28:31], v50, s[4:7], s62 offen offset:1024 sc1
  s_branch L_gdone_74
L_gv1_72:
  s_mov_b32 s59, 0
  s_mov_b32 s57, 0
L_gchunk_83:
  s_add_u32 s95, s59, 12
  s_lshl_b32 s94, s95, 2
  s_add_u32 s94, s94, 157184
  v_mov_b32 v160, s94
  s_mov_b32 s96, 0
L_ls_84:
  ds_read_b32 v161, v160
  s_add_u32 s96, s96, 1
  s_waitcnt lgkmcnt(0)
  v_readfirstlane_b32 s94, v161
  s_cmp_gt_u32 s96, 1048576
  s_cbranch_scc1 L_lsx_85
  s_cmp_ge_u32 s94, 4
  s_cbranch_scc1 L_lsx_85
  s_sleep 1
  s_branch L_ls_84
L_lsx_85:
  ds_read_b128 v[8:11], v40
  ds_read_b64_tr_b16 v[16:17], v44 offset:0
  ds_read_b64_tr_b16 v[18:19], v44 offset:768
  ds_read_b64_tr_b16 v[20:21], v44 offset:56
  ds_read_b64_tr_b16 v[22:23], v44 offset:824
  ds_read_b64_tr_b16 v[24:25], v44 offset:112
  ds_read_b64_tr_b16 v[26:27], v44 offset:880
  ds_read_b128 v[12:15], v41
  ds_read_b64_tr_b16 v[28:29], v44 offset:3072
  ds_read_b64_tr_b16 v[30:31], v44 offset:3840
  ds_read_b64_tr_b16 v[32:33], v44 offset:3128
  ds_read_b64_tr_b16 v[34:35], v44 offset:3896
  ds_read_b64_tr_b16 v[36:37], v44 offset:3184
  ds_read_b64_tr_b16 v[38:39], v44 offset:3952
  s_waitcnt lgkmcnt(7)
  v_mfma_f32_32x32x16_bf16 v[64:79], v[16:19], v[8:11], v[64:79]
  v_mfma_f32_32x32x16_bf16 v[80:95], v[20:23], v[8:11], v[80:95]
  v_mfma_f32_32x32x16_bf16 v[96:111], v[8:11], v[24:27], v[96:111]
  ds_read_b128 v[8:11], v42
  ds_read_b64_tr_b16 v[16:17], v44 offset:6144
  ds_read_b64_tr_b16 v[18:19], v44 offset:6912
  ds_read_b64_tr_b16 v[20:21], v44 offset:6200
  ds_read_b64_tr_b16 v[22:23], v44 offset:6968
  ds_read_b64_tr_b16 v[24:25], v44 offset:6256
  ds_read_b64_tr_b16 v[26:27], v44 offset:7024
  s_waitcnt lgkmcnt(7)
  v_mfma_f32_32x32x16_bf16 v[64:79], v[28:31], v[12:15], v[64:79]
  v_mfma_f32_32x32x16_bf16 v[80:95], v[32:35], v[12:15], v[80:95]
  v_mfma_f32_32x32x16_bf16 v[96:111], v[12:15], v[36:39], v[96:111]
  ds_read_b128 v[12:15], v43
  ds_read_b64_tr_b16 v[28:29], v44 offset:9216
  ds_read_b64_tr_b16 v[30:31], v44 offset:9984
  ds_read_b64_tr_b16 v[32:33], v44 offset:9272
  ds_read_b64_tr_b16 v[34:35], v44 offset:10040
  ds_read_b64_tr_b16 v[36:37], v44 offset:9328
  ds_read_b64_tr_b16 v[38:39], v44 offset:10096
  s_waitcnt lgkmcnt(7)
  v_mfma_f32_32x32x16_bf16 v[64:79], v[16:19], v[8:11], v[64:79]
  v_mfma_f32_32x32x16_bf16 v[80:95], v[20:23], v[8:11], v[80:95]
  v_mfma_f32_32x32x16_bf16 v[96:111], v[8:11], v[24:27], v[96:111]
  s_waitcnt lgkmcnt(0)
  s_cmp_eq_u32 s59, 6
  s_cselect_b32 s95, 4, s59
  s_cmp_gt_u32 s95, 4
  s_cbranch_scc1 L_nodn_86
  s_cmp_eq_u32 s59, 4
  s_cbranch_scc1 L_nodn_86
  s_add_u32 s95, s95, 20
  s_lshl_b32 s94, s95, 2
  s_add_u32 s94, s94, 157184
  v_mov_b32 v160, s94
  v_mov_b32 v161, 1
  s_mov_b64 exec, 1
  ds_add_u32 v160, v161
  s_mov_b64 exec, -1
L_nodn_86:
  v_mfma_f32_32x32x16_bf16 v[64:79], v[28:31], v[12:15], v[64:79]
  v_mfma_f32_32x32x16_bf16 v[80:95], v[32:35], v[12:15], v[80:95]
  v_mfma_f32_32x32x16_bf16 v[96:111], v[12:15], v[36:39], v[96:111]
  s_add_u32 s57, s57, 1
  s_cmp_eq_u32 s57, 3
  s_movk_i32 s88, 28672
  s_cbranch_scc0 L_nowrap_87
  s_mov_b32 s57, 0
  s_mov_b32 s88, 0xffff2000
L_nowrap_87:
  v_add_u32 v40, s88, v40
  v_add_u32 v41, s88, v41
  v_add_u32 v42, s88, v42
  v_add_u32 v43, s88, v43
  v_add_u32 v44, s88, v44
  s_add_u32 s59, s59, 1
  s_cmp_lt_u32 s59, 7
  s_cbranch_scc1 L_gchunk_83
  s_nop 10
  s_mul_i32 s88, s55, 3
  s_add_u32 s88, s88, 0
  s_cmp_ge_u32 s88, 16
  s_cbranch_scc1 L_nosc_88
  s_mov_b32 s88, 0x3e8b97f6
  v_mul_f32 v64, s88, v64
  v_mul_f32 v65, s88, v65
  v_mul_f32 v66, s88, v66
  v_mul_f32 v67, s88, v67
  v_mul_f32 v68, s88, v68
  v_mul_f32 v69, s88, v69
  v_mul_f32 v70, s88, v70
  v_mul_f32 v71, s88, v71
  v_mul_f32 v72, s88, v72
  v_mul_f32 v73, s88, v73
  v_mul_f32 v74, s88, v74
  v_mul_f32 v75, s88, v75
  v_mul_f32 v76, s88, v76
  v_mul_f32 v77, s88, v77
  v_mul_f32 v78, s88, v78
  v_mul_f32 v79, s88, v79
L_nosc_88:
  v_cvt_pk_bf16_f32 v8, v64, v65
  v_cvt_pk_bf16_f32 v9, v66, v67
  v_cvt_pk_bf16_f32 v10, v68, v69
  v_cvt_pk_bf16_f32 v11, v70, v71
  v_cvt_pk_bf16_f32 v12, v72, v73
  v_cvt_pk_bf16_f32 v13, v74, v75
  v_cvt_pk_bf16_f32 v14, v76, v77
  v_cvt_pk_bf16_f32 v15, v78, v79
  v_and_b32 v14, v14, v51
  v_and_b32 v15, v15, v51
  buffer_store_dwordx4 v[8:11], v50, s[4:7], s60 offen sc1
  buffer_store_dwordx4 v[12:15], v50, s[4:7], s60 offen offset:1024 sc1
  s_mul_i32 s88, s55, 3
  s_add_u32 s88, s88, 1
  s_cmp_ge_u32 s88, 16
  s_cbranch_scc1 L_nosc_89
  s_mov_b32 s88, 0x3e8b97f6
  v_mul_f32 v80, s88, v80
  v_mul_f32 v81, s88, v81
  v_mul_f32 v82, s88, v82
  v_mul_f32 v83, s88, v83
  v_mul_f32 v84, s88, v84
  v_mul_f32 v85, s88, v85
  v_mul_f32 v86, s88, v86
  v_mul_f32 v87, s88, v87
  v_mul_f32 v88, s88, v88
  v_mul_f32 v89, s88, v89
  v_mul_f32 v90, s88, v90
  v_mul_f32 v91, s88, v91
  v_mul_f32 v92, s88, v92
  v_mul_f32 v93, s88, v93
  v_mul_f32 v94, s88, v94
  v_mul_f32 v95, s88, v95
L_nosc_89:
  v_cvt_pk_bf16_f32 v16, v80, v81
  v_cvt_pk_bf16_f32 v17, v82, v83
  v_cvt_pk_bf16_f32 v18, v84, v85
  v_cvt_pk_bf16_f32 v19, v86, v87
  v_cvt_pk_bf16_f32 v20, v88, v89
  v_cvt_pk_bf16_f32 v21, v90, v91
  v_cvt_pk_bf16_f32 v22, v92, v93
  v_cvt_pk_bf16_f32 v23, v94, v95
  v_and_b32 v22, v22, v51
  v_and_b32 v23, v23, v51
  buffer_store_dwordx4 v[16:19], v50, s[4:7], s61 offen sc1
  buffer_store_dwordx4 v[20:23], v50, s[4:7], s61 offen offset:1024 sc1
  v_cvt_pk_bf16_f32 v24, v96, v97
  v_cvt_pk_bf16_f32 v25, v98, v99
  v_cvt_pk_bf16_f32 v26, v100, v101
  v_cvt_pk_bf16_f32 v27, v102, v103
  v_cvt_pk_bf16_f32 v28, v104, v105
  v_cvt_pk_bf16_f32 v29, v106, v107
  v_cvt_pk_bf16_f32 v30, v108, v109
  v_cvt_pk_bf16_f32 v31, v110, v111
  v_and_or_b32 v24, v24, v52, v53
  v_and_or_b32 v25, v25, v52, v53
  v_and_or_b32 v26, v26, v52, v53
  v_and_or_b32 v27, v27, v52, v53
  v_and_or_b32 v28, v28, v52, v53
  v_and_or_b32 v29, v29, v52, v53
  v_and_or_b32 v30, v30, v52, v53
  v_and_or_b32 v31, v31, v52, v53
  buffer_store_dwordx4 v[24:27], v50, s[4:7], s62 offen sc1
  buffer_store_dwordx4 v[28:31], v50, s[4:7], s62 offen offset:1024 sc1
  s_branch L_gdone_74
L_gv2_73:
  s_mov_b32 s59, 0
  s_mov_b32 s57, 0
L_gchunk_90:
  s_add_u32 s95, s59, 12
  s_lshl_b32 s94, s95, 2
  s_add_u32 s94, s94, 157184
  v_mov_b32 v160, s94
  s_mov_b32 s96, 0
L_ls_91:
  ds_read_b32 v161, v160
  s_add_u32 s96, s96, 1
  s_waitcnt lgkmcnt(0)
  v_readfirstlane_b32 s94, v161
  s_cmp_gt_u32 s96, 1048576
  s_cbranch_scc1 L_lsx_92
  s_cmp_ge_u32 s94, 4
  s_cbranch_scc1 L_lsx_92
  s_sleep 1
  s_branch L_ls_91
L_lsx_92:
  ds_read_b128 v[8:11], v40
  ds_read_b64_tr_b16 v[16:17], v44 offset:0
  ds_read_b64_tr_b16 v[18:19], v44 offset:768
  ds_read_b64_tr_b16 v[20:21], v44 offset:56
  ds_read_b64_tr_b16 v[22:23], v44 offset:824
  ds_read_b64_tr_b16 v[24:25], v44 offset:112
  ds_read_b64_tr_b16 v[26:27], v44 offset:880
  ds_read_b128 v[12:15], v41
  ds_read_b64_tr_b16 v[28:29], v44 offset:3072
  ds_read_b64_tr_b16 v[30:31], v44 offset:3840
  ds_read_b64_tr_b16 v[32:33], v44 offset:3128
  ds_read_b64_tr_b16 v[34:35], v44 offset:3896
  ds_read_b64_tr_b16 v[36:37], v44 offset:3184
  ds_read_b64_tr_b16 v[38:39], v44 offset:3952
  s_waitcnt lgkmcnt(7)
  v_mfma_f32_32x32x16_bf16 v[64:79], v[8:11], v[16:19], v[64:79]
  v_mfma_f32_32x32x16_bf16 v[80:95], v[8:11], v[20:23], v[80:95]
  v_mfma_f32_32x32x16_bf16 v[96:111], v[8:11], v[24:27], v[96:111]
  ds_read_b128 v[8:11], v42
  ds_read_b64_tr_b16 v[16:17], v44 offset:6144
  ds_read_b64_tr_b16 v[18:19], v44 offset:6912
  ds_read_b64_tr_b16 v[20:21], v44 offset:6200
  ds_read_b64_tr_b16 v[22:23], v44 offset:6968
  ds_read_b64_tr_b16 v[24:25], v44 offset:6256
  ds_read_b64_tr_b16 v[26:27], v44 offset:7024
  s_waitcnt lgkmcnt(7)
  v_mfma_f32_32x32x16_bf16 v[64:79], v[12:15], v[28:31], v[64:79]
  v_mfma_f32_32x32x16_bf16 v[80:95], v[12:15], v[32:35], v[80:95]
  v_mfma_f32_32x32x16_bf16 v[96:111], v[12:15], v[36:39], v[96:111]
  ds_read_b128 v[12:15], v43
  ds_read_b64_tr_b16 v[28:29], v44 offset:9216
  ds_read_b64_tr_b16 v[30:31], v44 offset:9984
  ds_read_b64_tr_b16 v[32:33], v44 offset:9272
  ds_read_b64_tr_b16 v[34:35], v44 offset:10040
  ds_read_b64_tr_b16 v[36:37], v44 offset:9328
  ds_read_b64_tr_b16 v[38:39], v44 offset:10096
  s_waitcnt lgkmcnt(7)
  v_mfma_f32_32x32x16_bf16 v[64:79], v[8:11], v[16:19], v[64:79]
  v_mfma_f32_32x32x16_bf16 v[80:95], v[8:11], v[20:23], v[80:95]
  v_mfma_f32_32x32x16_bf16 v[96:111], v[8:11], v[24:27], v[96:111]
  s_waitcnt lgkmcnt(0)
  s_cmp_eq_u32 s59, 6
  s_cselect_b32 s95, 4, s59
  s_cmp_gt_u32 s95, 4
  s_cbranch_scc1 L_nodn_93
  s_cmp_eq_u32 s59, 4
  s_cbranch_scc1 L_nodn_93
  s_add_u32 s95, s95, 20
  s_lshl_b32 s94, s95, 2
  s_add_u32 s94, s94, 157184
  v_mov_b32 v160, s94
  v_mov_b32 v161, 1
  s_mov_b64 exec, 1
  ds_add_u32 v160, v161
  s_mov_b64 exec, -1
L_nodn_93:
  v_mfma_f32_32x32x16_bf16 v[64:79], v[12:15], v[28:31], v[64:79]
  v_mfma_f32_32x32x16_bf16 v[80:95], v[12:15], v[32:35], v[80:95]
  v_mfma_f32_32x32x16_bf16 v[96:111], v[12:15], v[36:39], v[96:111]
  s_add_u32 s57, s57, 1
  s_cmp_eq_u32 s57, 3
  s_movk_i32 s88, 28672
  s_cbranch_scc0 L_nowrap_94
  s_mov_b32 s57, 0
  s_mov_b32 s88, 0xffff2000
L_nowrap_94:
  v_add_u32 v40, s88, v40
  v_add_u32 v41, s88, v41
  v_add_u32 v42, s88, v42
  v_add_u32 v43, s88, v43
  v_add_u32 v44, s88, v44
  s_add_u32 s59, s59, 1
  s_cmp_lt_u32 s59, 7
  s_cbranch_scc1 L_gchunk_90
  s_nop 10
  v_cvt_pk_bf16_f32 v8, v64, v65
  v_cvt_pk_bf16_f32 v9, v66, v67
  v_cvt_pk_bf16_f32 v10, v68, v69
  v_cvt_pk_bf16_f32 v11, v70, v71
  v_cvt_pk_bf16_f32 v12, v72, v73
  v_cvt_pk_bf16_f32 v13, v74, v75
  v_cvt_pk_bf16_f32 v14, v76, v77
  v_cvt_pk_bf16_f32 v15, v78, v79
  v_and_or_b32 v8, v8, v52, v53
  v_and_or_b32 v9, v9, v52, v53
  v_and_or_b32 v10, v10, v52, v53
  v_and_or_b32 v11, v11, v52, v53
  v_and_or_b32 v12, v12, v52, v53
  v_and_or_b32 v13, v13, v52, v53
  v_and_or_b32 v14, v14, v52, v53
  v_and_or_b32 v15, v15, v52, v53
  buffer_store_dwordx4 v[8:11], v50, s[4:7], s60 offen sc1
  buffer_store_dwordx4 v[12:15], v50, s[4:7], s60 offen offset:1024 sc1
  v_cvt_pk_bf16_f32 v16, v80, v81
  v_cvt_pk_bf16_f32 v17, v82, v83
  v_cvt_pk_bf16_f32 v18, v84, v85
  v_cvt_pk_bf16_f32 v19, v86, v87
  v_cvt_pk_bf16_f32 v20, v88, v89
  v_cvt_pk_bf16_f32 v21, v90, v91
  v_cvt_pk_bf16_f32 v22, v92, v93
  v_cvt_pk_bf16_f32 v23, v94, v95
  v_and_or_b32 v16, v16, v52, v53
  v_and_or_b32 v17, v17, v52, v53
  v_and_or_b32 v18, v18, v52, v53
  v_and_or_b32 v19, v19, v52, v53
  v_and_or_b32 v20, v20, v52, v53
  v_and_or_b32 v21, v21, v52, v53
  v_and_or_b32 v22, v22, v52, v53
  v_and_or_b32 v23, v23, v52, v53
  buffer_store_dwordx4 v[16:19], v50, s[4:7], s61 offen sc1
  buffer_store_dwordx4 v[20:23], v50, s[4:7], s61 offen offset:1024 sc1
  v_cvt_pk_bf16_f32 v24, v96, v97
  v_cvt_pk_bf16_f32 v25, v98, v99
  v_cvt_pk_bf16_f32 v26, v100, v101
  v_cvt_pk_bf16_f32 v27, v102, v103
  v_cvt_pk_bf16_f32 v28, v104, v105
  v_cvt_pk_bf16_f32 v29, v106, v107
  v_cvt_pk_bf16_f32 v30, v108, v109
  v_cvt_pk_bf16_f32 v31, v110, v111
  v_and_or_b32 v24, v24, v52, v53
  v_and_or_b32 v25, v25, v52, v53
  v_and_or_b32 v26, v26, v52, v53
  v_and_or_b32 v27, v27, v52, v53
  v_and_or_b32 v28, v28, v52, v53
  v_and_or_b32 v29, v29, v52, v53
  v_and_or_b32 v30, v30, v52, v53
  v_and_or_b32 v31, v31, v52, v53
  buffer_store_dwordx4 v[24:27], v50, s[4:7], s62 offen sc1
  buffer_store_dwordx4 v[28:31], v50, s[4:7], s62 offen offset:1024 sc1
L_gdone_74:
  s_lshl_b32 s57, s55, 4
  s_add_u32 s57, s57, s54
  s_waitcnt vmcnt(0)
  v_mov_b32 v160, 157184
  v_mov_b32 v161, 1
  s_mov_b64 exec, 1
  ds_add_rtn_u32 v161, v160, v161
  s_waitcnt lgkmcnt(0)
  s_mov_b64 exec, -1
  v_readfirstlane_b32 s94, v161
  s_nop 3
  s_cmp_lg_u32 s94, 3
  s_cbranch_scc1 L_sl_95
  s_lshl_b32 s94, s57, 4
  s_add_u32 s94, s94, 13635584
  v_mov_b32 v160, s93
  v_mov_b32 v161, 0
  s_mov_b64 exec, 1
  buffer_store_dword v160, v161, s[4:7], s94 offen sc1
  s_mov_b64 exec, -1
L_sl_95:
  s_and_b32 s52, s2, 7
  s_lshr_b32 s53, s2, 3
  s_and_b32 s54, s53, 1
  s_lshl_b32 s52, s52, 1
  s_add_u32 s52, s52, s54
  s_lshr_b32 s53, s53, 1
  s_add_u32 s88, s52, 16
  s_mul_i32 s88, s88, 21846
  s_lshr_b32 s88, s88, 16
  s_add_u32 s89, s52, 32
  s_mul_i32 s89, s89, 21846
  s_lshr_b32 s89, s89, 16
  s_mul_i32 s90, s52, 21846
  s_lshr_b32 s90, s90, 16
  s_lshl_b32 s90, s90, 4
  s_add_u32 s90, s90, s53
  s_lshl_b32 s88, s88, 4
  s_lshl_b32 s89, s89, 4
  v_and_b32 v158, 15, v1
  v_add_u32 v163, s88, v158
  v_add_u32 v164, s89, v158
  v_cmp_lt_u32 vcc, 15, v1
  v_mov_b32 v165, s90
  s_nop 0
  v_cndmask_b32 v158, v163, v164, vcc
  v_cmp_lt_u32 vcc, 31, v1
  s_nop 1
  v_cndmask_b32 v158, v158, v165, vcc
  v_lshlrev_b32 v158, 4, v158
  v_add_u32 v158, 13635584, v158
  s_and_b32 s54, s3, 3
  s_lshr_b32 s55, s3, 2
  v_lshlrev_b32 v4, 4, v1
  s_lshl_b32 s58, s3, 12
  s_lshl_b32 s59, s55, 14
  s_lshl_b32 s92, s53, 2
  s_add_u32 s92, s92, s54
  s_lshl_b32 s92, s92, 4
  s_add_u32 s92, s92, s52
  s_lshl_b32 s92, s92, 11
  s_add_u32 s92, s92, 10485760
  s_lshl_b32 s88, s54, 12
  s_add_u32 s88, s88, 81920
  v_add_u32 v157, s88, v4
  v_cmp_gt_u32 vcc, 32, v1
  v_mov_b32 v156, 0
  s_nop 0
  v_cndmask_b32 v156, v156, -1, vcc
  v_mov_b32 v16, 0
  v_mov_b32 v17, 0
  v_mov_b32 v18, 0
  v_mov_b32 v19, 0
  v_mov_b32 v20, 0
  v_mov_b32 v21, 0
  v_mov_b32 v22, 0
  v_mov_b32 v23, 0
  v_mov_b32 v24, 0
  v_mov_b32 v25, 0
  v_mov_b32 v26, 0
  v_mov_b32 v27, 0
  v_mov_b32 v28, 0
  v_mov_b32 v29, 0
  v_mov_b32 v30, 0
  v_mov_b32 v31, 0
  s_mov_b32 s101, 0
  s_lshl_b32 s57, s52, 18
  s_add_u32 s57, s57, s58
  s_add_u32 s57, s57, 2162688
  s_mov_b32 s56, 0x00300030
  v_add_u32 v2, s59, v4
  v_add_u32 v3, 32768, v2
  v_mov_b32 v88, 0
  v_mov_b32 v89, 0
  v_mov_b32 v90, 0
  v_mov_b32 v91, 0
  v_mov_b32 v92, 0
  v_mov_b32 v93, 0
  v_mov_b32 v94, 0
  v_mov_b32 v95, 0
  v_mov_b32 v96, 0
  v_mov_b32 v97, 0
  v_mov_b32 v98, 0
  v_mov_b32 v99, 0
  v_mov_b32 v100, 0
  v_mov_b32 v101, 0
  v_mov_b32 v102, 0
  v_mov_b32 v103, 0
  v_mov_b32 v68, 0
  v_mov_b32 v69, 0
  v_mov_b32 v70, 0
  v_mov_b32 v71, 0
  s_mov_b32 s60, 65536
  s_mov_b32 s61, 0
  s_mov_b32 s98, 0
  s_movk_i32 s95, 4
  s_lshl_b32 s94, s95, 2
  s_add_u32 s94, s94, 157184
  v_mov_b32 v160, s94
  s_mov_b32 s96, 0
L_ls_96:
  ds_read_b32 v161, v160
  s_add_u32 s96, s96, 1
  s_waitcnt lgkmcnt(0)
  v_readfirstlane_b32 s94, v161
  s_cmp_gt_u32 s96, 1048576
  s_cbranch_scc1 L_lsx_97
  s_cmp_ge_u32 s94, 1
  s_cbranch_scc1 L_lsx_97
  s_sleep 1
  s_branch L_ls_96
L_lsx_97:
L_join_1:
  s_movk_i32 s95, 24
  s_lshl_b32 s94, s95, 2
  s_add_u32 s94, s94, 157184
  v_mov_b32 v160, s94
  s_mov_b32 s96, 0
L_ls_98:
  ds_read_b32 v161, v160
  s_add_u32 s96, s96, 1
  s_waitcnt lgkmcnt(0)
  v_readfirstlane_b32 s94, v161
  s_cmp_gt_u32 s96, 1048576
  s_cbranch_scc1 L_lsx_99
  s_cmp_ge_u32 s94, 4
  s_cbranch_scc1 L_lsx_99
  s_sleep 1
  s_branch L_ls_98
L_lsx_99:
  s_sub_u32 s88, s57, 65536
  s_mov_b32 m0, s58
  s_nop 0
  buffer_load_dwordx4 v4, s[4:7], s88 offen offset:0 sc1 lds
  buffer_load_dwordx4 v4, s[4:7], s88 offen offset:1024 sc1 lds
  buffer_load_dwordx4 v4, s[4:7], s88 offen offset:2048 sc1 lds
  buffer_load_dwordx4 v4, s[4:7], s88 offen offset:3072 sc1 lds
  s_and_b32 s88, s3, 3
  s_lshl_b32 s89, s52, 6
  s_lshl_b32 s90, s53, 2
  s_add_u32 s89, s89, s90
  s_add_u32 s89, s89, s88
  s_lshl_b32 s89, s89, 11
  s_add_u32 s89, s89, 0
  v_lshlrev_b32 v166, 4, v1
  buffer_load_dwordx4 v[144:147], v166, s[4:7], s89 offen sc1
  buffer_load_dwordx4 v[148:151], v166, s[4:7], s89 offen offset:1024 sc1
  s_waitcnt vmcnt(0)
  v_mov_b32 v160, 157224
  v_mov_b32 v161, 1
  s_mov_b64 exec, 1
  ds_add_u32 v160, v161
  s_mov_b64 exec, -1
  s_movk_i32 s95, 10
  s_lshl_b32 s94, s95, 2
  s_add_u32 s94, s94, 157184
  v_mov_b32 v160, s94
  s_mov_b32 s96, 0
L_ls_100:
  ds_read_b32 v161, v160
  s_add_u32 s96, s96, 1
  s_waitcnt lgkmcnt(0)
  v_readfirstlane_b32 s94, v161
  s_cmp_gt_u32 s96, 1048576
  s_cbranch_scc1 L_lsx_101
  s_cmp_ge_u32 s94, 8
  s_cbranch_scc1 L_lsx_101
  s_sleep 1
  s_branch L_ls_100
L_lsx_101:
  ds_read_b128 v[72:75], v2 offset:0
  ds_read_b128 v[76:79], v2 offset:1024
  s_sub_u32 s88, s57, 32768
  s_add_u32 m0, s58, 32768
  s_nop 0
  buffer_load_dwordx4 v4, s[4:7], s88 offen offset:0 sc1 lds
  buffer_load_dwordx4 v4, s[4:7], s88 offen offset:1024 sc1 lds
  buffer_load_dwordx4 v4, s[4:7], s88 offen offset:2048 sc1 lds
  buffer_load_dwordx4 v4, s[4:7], s88 offen offset:3072 sc1 lds
  s_waitcnt lgkmcnt(0)
  v_mfma_f32_32x32x16_bf16 v[32:47], v[72:75], v[144:147], v[16:31]
  v_mfma_f32_32x32x16_bf16 v[32:47], v[76:79], v[148:151], v[32:47]
  ds_read_b128 v[72:75], v2 offset:4096
  ds_read_b128 v[84:87], v2 offset:3072
  ds_read_b128 v[76:79], v2 offset:5120
  ds_read_b128 v[80:83], v2 offset:2048
  s_nop 7
  s_setprio 1
  s_cmp_lt_u32 s3, 4
  s_cbranch_scc1 L_sp_102
  s_setprio 2
L_sp_102:
.p2align 6
L_atloop_103:
  s_waitcnt lgkmcnt(2)
  v_mfma_f32_32x32x16_bf16 v[48:63], v[72:75], v[144:147], v[16:31]
  ds_read_b128 v[72:75], v2 offset:8192
  v_exp_f32 v32, v32
  v_exp_f32 v33, v33
  v_exp_f32 v34, v34
  v_exp_f32 v35, v35
  v_mfma_f32_32x32x16_bf16 v[88:103], v[84:87], v[68:71], v[88:103]
  ds_read_b128 v[84:87], v2 offset:3072
  v_exp_f32 v36, v36
  v_exp_f32 v37, v37
  v_cvt_pk_bf16_f32 v64, v32, v33
  v_cvt_pk_bf16_f32 v65, v34, v35
  v_exp_f32 v38, v38
  s_waitcnt lgkmcnt(2)
  v_mfma_f32_32x32x16_bf16 v[48:63], v[76:79], v[148:151], v[48:63]
  ds_read_b128 v[76:79], v2 offset:9216
  v_exp_f32 v39, v39
  v_exp_f32 v40, v40
  v_cvt_pk_bf16_f32 v66, v36, v37
  v_exp_f32 v41, v41
  v_exp_f32 v42, v42
  v_cvt_pk_bf16_f32 v67, v38, v39
  v_exp_f32 v43, v43
  v_exp_f32 v44, v44
  v_mfma_f32_32x32x16_bf16 v[88:103], v[80:83], v[64:67], v[88:103]
  ds_read_b128 v[80:83], v2 offset:6144
  v_exp_f32 v45, v45
  v_exp_f32 v46, v46
  v_exp_f32 v47, v47
  v_cvt_pk_bf16_f32 v68, v40, v41
  v_cvt_pk_bf16_f32 v69, v42, v43
  v_cvt_pk_bf16_f32 v70, v44, v45
  v_cvt_pk_bf16_f32 v71, v46, v47
  s_waitcnt lgkmcnt(2)
  v_mfma_f32_32x32x16_bf16 v[32:47], v[72:75], v[144:147], v[16:31]
  ds_read_b128 v[72:75], v2 offset:12288
  v_exp_f32 v48, v48
  v_exp_f32 v49, v49
  v_exp_f32 v50, v50
  v_exp_f32 v51, v51
  v_mfma_f32_32x32x16_bf16 v[88:103], v[84:87], v[68:71], v[88:103]
  ds_read_b128 v[84:87], v2 offset:7168
  v_exp_f32 v52, v52
  v_exp_f32 v53, v53
  v_cvt_pk_bf16_f32 v64, v48, v49
  v_cvt_pk_bf16_f32 v65, v50, v51
  v_exp_f32 v54, v54
  s_waitcnt lgkmcnt(2)
  v_mfma_f32_32x32x16_bf16 v[32:47], v[76:79], v[148:151], v[32:47]
  ds_read_b128 v[76:79], v2 offset:13312
  v_exp_f32 v55, v55
  v_exp_f32 v56, v56
  v_cvt_pk_bf16_f32 v66, v52, v53
  v_exp_f32 v57, v57
  v_exp_f32 v58, v58
  v_cvt_pk_bf16_f32 v67, v54, v55
  v_exp_f32 v59, v59
  v_exp_f32 v60, v60
  v_mfma_f32_32x32x16_bf16 v[88:103], v[80:83], v[64:67], v[88:103]
  ds_read_b128 v[80:83], v2 offset:10240
  v_exp_f32 v61, v61
  v_exp_f32 v62, v62
  v_exp_f32 v63, v63
  v_cvt_pk_bf16_f32 v68, v56, v57
  v_cvt_pk_bf16_f32 v69, v58, v59
  v_cvt_pk_bf16_f32 v70, v60, v61
  v_cvt_pk_bf16_f32 v71, v62, v63
  s_waitcnt vmcnt(0)
  s_barrier
  s_waitcnt lgkmcnt(2)
  v_mfma_f32_32x32x16_bf16 v[48:63], v[72:75], v[144:147], v[16:31]
  ds_read_b128 v[72:75], v3 offset:0
  v_exp_f32 v32, v32
  v_exp_f32 v33, v33
  v_exp_f32 v34, v34
  v_exp_f32 v35, v35
  v_mfma_f32_32x32x16_bf16 v[88:103], v[84:87], v[68:71], v[88:103]
  ds_read_b128 v[84:87], v2 offset:11264
  v_exp_f32 v36, v36
  v_exp_f32 v37, v37
  v_cvt_pk_bf16_f32 v64, v32, v33
  v_cvt_pk_bf16_f32 v65, v34, v35
  v_exp_f32 v38, v38
  s_waitcnt lgkmcnt(2)
  v_mfma_f32_32x32x16_bf16 v[48:63], v[76:79], v[148:151], v[48:63]
  ds_read_b128 v[76:79], v3 offset:1024
  v_exp_f32 v39, v39
  v_exp_f32 v40, v40
  v_cvt_pk_bf16_f32 v66, v36, v37
  v_exp_f32 v41, v41
  v_exp_f32 v42, v42
  v_cvt_pk_bf16_f32 v67, v38, v39
  v_exp_f32 v43, v43
  v_exp_f32 v44, v44
  v_mfma_f32_32x32x16_bf16 v[88:103], v[80:83], v[64:67], v[88:103]
  ds_read_b128 v[80:83], v2 offset:14336
  v_exp_f32 v45, v45
  v_exp_f32 v46, v46
  v_exp_f32 v47, v47
  v_cvt_pk_bf16_f32 v68, v40, v41
  v_cvt_pk_bf16_f32 v69, v42, v43
  v_cvt_pk_bf16_f32 v70, v44, v45
  v_cvt_pk_bf16_f32 v71, v46, v47
  s_waitcnt lgkmcnt(2)
  v_mfma_f32_32x32x16_bf16 v[32:47], v[72:75], v[144:147], v[16:31]
  ds_read_b128 v[72:75], v3 offset:4096
  v_exp_f32 v48, v48
  v_exp_f32 v49, v49
  v_exp_f32 v50, v50
  v_exp_f32 v51, v51
  v_mfma_f32_32x32x16_bf16 v[88:103], v[84:87], v[68:71], v[88:103]
  ds_read_b128 v[84:87], v2 offset:15360
  v_exp_f32 v52, v52
  v_exp_f32 v53, v53
  v_cvt_pk_bf16_f32 v64, v48, v49
  v_cvt_pk_bf16_f32 v65, v50, v51
  v_exp_f32 v54, v54
  s_waitcnt lgkmcnt(2)
  v_mfma_f32_32x32x16_bf16 v[32:47], v[76:79], v[148:151], v[32:47]
  ds_read_b128 v[76:79], v3 offset:5120
  v_exp_f32 v55, v55
  v_exp_f32 v56, v56
  v_cvt_pk_bf16_f32 v66, v52, v53
  v_exp_f32 v57, v57
  v_exp_f32 v58, v58
  v_cvt_pk_bf16_f32 v67, v54, v55
  v_exp_f32 v59, v59
  v_exp_f32 v60, v60
  v_mfma_f32_32x32x16_bf16 v[88:103], v[80:83], v[64:67], v[88:103]
  ds_read_b128 v[80:83], v3 offset:2048
  v_exp_f32 v61, v61
  v_exp_f32 v62, v62
  v_exp_f32 v63, v63
  v_cvt_pk_bf16_f32 v68, v56, v57
  v_cvt_pk_bf16_f32 v69, v58, v59
  v_cvt_pk_bf16_f32 v70, v60, v61
  v_cvt_pk_bf16_f32 v71, v62, v63
  s_add_u32 s60, s60, 32768
  s_cmp_eq_u32 s60, 98304
  s_cselect_b32 s60, 0, s60
  v_mov_b32 v2, v3
  s_add_u32 s88, s60, 65536
  s_cmp_ge_u32 s88, 98304
  s_cselect_b32 s89, 98304, 0
  s_sub_u32 s88, s88, s89
  s_add_u32 s88, s88, s59
  v_add_u32 v3, s88, v4
  s_add_u32 s61, s61, 1
  s_cmp_lt_u32 s61, 8
  s_cbranch_scc1 L_atloop_103
  s_setprio 0
  s_waitcnt vmcnt(0) lgkmcnt(0)
  v_mfma_f32_32x32x16_bf16 v[88:103], v[84:87], v[68:71], v[88:103]
  s_cmp_eq_u32 s55, 0
  s_cbranch_scc1 L_c0_104
  s_nop 11
  ds_write_b128 v157, v[88:91] offset:0
  ds_write_b128 v157, v[92:95] offset:1024
  ds_write_b128 v157, v[96:99] offset:2048
  ds_write_b128 v157, v[100:103] offset:3072
  s_waitcnt lgkmcnt(0)
L_c0_104:
  s_barrier
L_tailtop_105:
  s_cmp_ge_u32 s3, 4
  s_cbranch_scc1 L_tailh_106
  ds_read_b128 v[32:35], v157 offset:0
  ds_read_b128 v[36:39], v157 offset:1024
  ds_read_b128 v[40:43], v157 offset:2048
  ds_read_b128 v[44:47], v157 offset:3072
  s_nop 1
  s_waitcnt lgkmcnt(0)
  v_pk_add_f32 v[88:89], v[88:89], v[32:33]
  v_pk_add_f32 v[90:91], v[90:91], v[34:35]
  v_pk_add_f32 v[92:93], v[92:93], v[36:37]
  v_pk_add_f32 v[94:95], v[94:95], v[38:39]
  v_pk_add_f32 v[96:97], v[96:97], v[40:41]
  v_pk_add_f32 v[98:99], v[98:99], v[42:43]
  v_pk_add_f32 v[100:101], v[100:101], v[44:45]
  v_pk_add_f32 v[102:103], v[102:103], v[46:47]
  v_mov_b32 v8, v100
  v_mov_b32 v9, v100
  s_nop 1
  v_permlane32_swap_b32 v8, v9
  s_nop 0
  v_rcp_f32 v6, v9
  v_and_b32 v100, v100, v156
  v_mov_b32 v7, v6
  v_pk_mul_f32 v[88:89], v[88:89], v[6:7]
  v_pk_mul_f32 v[90:91], v[90:91], v[6:7]
  v_pk_mul_f32 v[92:93], v[92:93], v[6:7]
  v_pk_mul_f32 v[94:95], v[94:95], v[6:7]
  v_pk_mul_f32 v[96:97], v[96:97], v[6:7]
  v_pk_mul_f32 v[98:99], v[98:99], v[6:7]
  v_pk_mul_f32 v[100:101], v[100:101], v[6:7]
  v_pk_mul_f32 v[102:103], v[102:103], v[6:7]
  v_cvt_pk_bf16_f32 v64, v88, v89
  v_cvt_pk_bf16_f32 v65, v90, v91
  v_cvt_pk_bf16_f32 v66, v92, v93
  v_cvt_pk_bf16_f32 v67, v94, v95
  v_cvt_pk_bf16_f32 v68, v96, v97
  v_cvt_pk_bf16_f32 v69, v98, v99
  v_cvt_pk_bf16_f32 v70, v100, v101
  v_cvt_pk_bf16_f32 v71, v102, v103
  buffer_store_dwordx4 v[64:67], v4, s[4:7], s92 offen sc1
  buffer_store_dwordx4 v[68:71], v4, s[4:7], s92 offen offset:1024 sc1
  s_cmp_lg_u32 s101, 0
  s_cbranch_scc1 L_nover_109
  v_mov_b32 v10, 0
  v_mov_b32 v11, 0
  v_mov_b32 v12, 0
  v_mov_b32 v13, 0
  v_pk_fma_f32 v[10:11], v[88:89], v[12:13], v[10:11]
  v_pk_fma_f32 v[10:11], v[90:91], v[12:13], v[10:11]
  v_pk_fma_f32 v[10:11], v[92:93], v[12:13], v[10:11]
  v_pk_fma_f32 v[10:11], v[94:95], v[12:13], v[10:11]
  v_pk_fma_f32 v[10:11], v[96:97], v[12:13], v[10:11]
  v_pk_fma_f32 v[10:11], v[98:99], v[12:13], v[10:11]
  v_pk_fma_f32 v[10:11], v[100:101], v[12:13], v[10:11]
  v_pk_fma_f32 v[10:11], v[102:103], v[12:13], v[10:11]
  s_mov_b32 s88, 0x30800000
  s_mov_b32 s89, 0x4e800000
  v_add_f32 v10, v10, v11
  v_cmp_nle_f32 s[90:91], s88, v9
  v_cmp_nge_f32 s[96:97], s89, v9
  v_cmp_u_f32 vcc, v10, v10
  s_nop 1
  s_or_b64 s[90:91], s[90:91], s[96:97]
  s_nop 1
  s_or_b64 s[90:91], s[90:91], vcc
  s_cmp_eq_u64 s[90:91], 0
  s_cbranch_scc1 L_good_110
  v_mov_b32 v160, 157300
  v_mov_b32 v161, 1
  s_mov_b64 exec, 1
  ds_add_u32 v160, v161
  s_mov_b64 exec, -1
L_good_110:
  v_mov_b32 v160, 157292
  v_mov_b32 v161, 1
  s_mov_b64 exec, 1
  ds_add_u32 v160, v161
  s_mov_b64 exec, -1
L_nover_109:
  s_cmp_lg_u32 s101, 0
  s_cbranch_scc1 L_vd_111
  s_movk_i32 s95, 27
  s_lshl_b32 s94, s95, 2
  s_add_u32 s94, s94, 157184
  v_mov_b32 v160, s94
  s_mov_b32 s96, 0
L_ls_112:
  ds_read_b32 v161, v160
  s_add_u32 s96, s96, 1
  s_waitcnt lgkmcnt(0)
  v_readfirstlane_b32 s94, v161
  s_cmp_gt_u32 s96, 1048576
  s_cbranch_scc1 L_lsx_113
  s_cmp_ge_u32 s94, 4
  s_cbranch_scc1 L_lsx_113
  s_sleep 1
  s_branch L_ls_112
L_lsx_113:
  v_mov_b32 v160, 157300
  ds_read_b32 v161, v160
  s_waitcnt lgkmcnt(0)
  v_readfirstlane_b32 s94, v161
  s_nop 3
  s_cmp_lg_u32 s94, 0
  s_cbranch_scc1 L_fallback_108
L_vd_111:
  s_lshl_b32 s58, s53, 4
  s_add_u32 s58, s58, s52
  s_cmp_ge_u32 s2, 224
  s_cbranch_scc1 L_no3_114
  s_and_b32 s52, s2, 7
  s_lshr_b32 s53, s2, 3
  s_mul_i32 s54, s53, 9363
  s_lshr_b32 s54, s54, 16
  s_mul_i32 s55, s54, 7
  s_sub_u32 s55, s53, s55
  s_lshl_b32 s52, s52, 2
  s_add_u32 s54, s54, s52
  s_waitcnt vmcnt(0)
  v_mov_b32 v160, 157188
  v_mov_b32 v161, 1
  s_mov_b64 exec, 1
  ds_add_rtn_u32 v161, v160, v161
  s_waitcnt lgkmcnt(0)
  s_mov_b64 exec, -1
  v_readfirstlane_b32 s94, v161
  s_nop 3
  s_cmp_lg_u32 s94, 3
  s_cbranch_scc1 L_sl_115
  s_lshl_b32 s94, s58, 4
  s_add_u32 s94, s94, 13643776
  v_mov_b32 v160, s93
  v_mov_b32 v161, 0
  s_mov_b64 exec, 1
  buffer_store_dword v160, v161, s[4:7], s94 offen sc1
  s_mov_b64 exec, -1
L_sl_115:
  s_and_b32 s56, s3, 1
  s_lshr_b32 s57, s3, 1
  s_lshr_b32 s59, s54, 1
  s_lshl_b32 s59, s59, 4
  s_lshl_b32 s60, s57, 3
  s_add_u32 s59, s59, s60
  v_and_b32 v2, 7, v1
  v_add_u32 v2, s59, v2
  v_lshlrev_b32 v2, 4, v2
  v_add_u32 v2, 13643776, v2
  v_lshrrev_b32 v11, 5, v1
  v_bfe_u32 v12, v1, 2, 2
  v_lshl_add_u32 v11, v11, 2, v12
  v_lshlrev_b32 v11, 7, v11
  v_bfe_u32 v13, v1, 4, 1
  v_bfe_u32 v14, v1, 1, 1
  v_lshl_add_u32 v13, v13, 1, v14
  v_lshrrev_b32 v12, 1, v12
  v_lshlrev_b32 v12, 2, v12
  v_and_b32 v14, 1, v1
  v_lshl_add_u32 v11, v14, 3, v11
  s_mul_i32 s59, s57, 28672
  s_add_u32 s59, s59, 98304
  v_add_u32 v11, s59, v11
  v_xor_b32 v14, v13, v12
  v_lshl_add_u32 v9, v14, 4, v11
  v_add_u32 v13, 4, v13
  v_xor_b32 v14, v13, v12
  v_lshl_add_u32 v10, v14, 4, v11
  v_mov_b32 v16, 0
  v_mov_b32 v17, 0
  v_mov_b32 v18, 0
  v_mov_b32 v19, 0
  v_mov_b32 v20, 0
  v_mov_b32 v21, 0
  v_mov_b32 v22, 0
  v_mov_b32 v23, 0
  v_mov_b32 v24, 0
  v_mov_b32 v25, 0
  v_mov_b32 v26, 0
  v_mov_b32 v27, 0
  v_mov_b32 v28, 0
  v_mov_b32 v29, 0
  v_mov_b32 v30, 0
  v_mov_b32 v31, 0
  v_mov_b32 v32, 0
  v_mov_b32 v33, 0
  v_mov_b32 v34, 0
  v_mov_b32 v35, 0
  v_mov_b32 v36, 0
  v_mov_b32 v37, 0
  v_mov_b32 v38, 0
  v_mov_b32 v39, 0
  v_mov_b32 v40, 0
  v_mov_b32 v41, 0
  v_mov_b32 v42, 0
  v_mov_b32 v43, 0
  v_mov_b32 v44, 0
  v_mov_b32 v45, 0
  v_mov_b32 v46, 0
  v_mov_b32 v47, 0
  s_mov_b32 s94, 0
L_poll_116:
  buffer_load_dword v162, v2, s[4:7], 0 offen sc1
  s_add_u32 s94, s94, 1
  s_cmp_gt_u32 s94, 65536
  s_waitcnt vmcnt(0)
  s_cbranch_scc1 L_pollx_117
  v_cmp_ne_u32 vcc, s93, v162
  s_cbranch_vccz L_pollx_117
  s_sleep 1
  s_branch L_poll_116
L_pollx_117:
  v_lshlrev_b32 v5, 4, v1
  s_lshl_b32 s58, s54, 1
  s_add_u32 s58, s58, s56
  s_lshl_b32 s58, s58, 15
  s_lshl_b32 s59, s57, 14
  s_add_u32 s58, s58, s59
  s_add_u32 s58, s58, 10485760
  buffer_load_dwordx4 v[64:67], v5, s[4:7], s58 offen offset:0 sc1
  buffer_load_dwordx4 v[68:71], v5, s[4:7], s58 offen offset:1024 sc1
  buffer_load_dwordx4 v[72:75], v5, s[4:7], s58 offen offset:2048 sc1
  buffer_load_dwordx4 v[76:79], v5, s[4:7], s58 offen offset:3072 sc1
  s_add_u32 s58, s58, 4096
  buffer_load_dwordx4 v[80:83], v5, s[4:7], s58 offen offset:0 sc1
  buffer_load_dwordx4 v[84:87], v5, s[4:7], s58 offen offset:1024 sc1
  buffer_load_dwordx4 v[88:91], v5, s[4:7], s58 offen offset:2048 sc1
  buffer_load_dwordx4 v[92:95], v5, s[4:7], s58 offen offset:3072 sc1
  s_add_u32 s58, s58, 4096
  buffer_load_dwordx4 v[96:99], v5, s[4:7], s58 offen offset:0 sc1
  buffer_load_dwordx4 v[100:103], v5, s[4:7], s58 offen offset:1024 sc1
  buffer_load_dwordx4 v[104:107], v5, s[4:7], s58 offen offset:2048 sc1
  buffer_load_dwordx4 v[108:111], v5, s[4:7], s58 offen offset:3072 sc1
  s_add_u32 s58, s58, 4096
  buffer_load_dwordx4 v[112:115], v5, s[4:7], s58 offen offset:0 sc1
  buffer_load_dwordx4 v[116:119], v5, s[4:7], s58 offen offset:1024 sc1
  buffer_load_dwordx4 v[120:123], v5, s[4:7], s58 offen offset:2048 sc1
  buffer_load_dwordx4 v[124:127], v5, s[4:7], s58 offen offset:3072 sc1
  ds_read_b64_tr_b16 v[48:49], v9 offset:0
  ds_read_b64_tr_b16 v[50:51], v9 offset:1024
  ds_read_b64_tr_b16 v[52:53], v10 offset:0
  ds_read_b64_tr_b16 v[54:55], v10 offset:1024
  ds_read_b64_tr_b16 v[56:57], v9 offset:2048
  ds_read_b64_tr_b16 v[58:59], v9 offset:3072
  ds_read_b64_tr_b16 v[60:61], v10 offset:2048
  ds_read_b64_tr_b16 v[62:63], v10 offset:3072
  s_waitcnt vmcnt(15) lgkmcnt(4)
  v_mfma_f32_32x32x16_bf16 v[16:31], v[48:51], v[64:67], v[16:31]
  v_mfma_f32_32x32x16_bf16 v[32:47], v[52:55], v[64:67], v[32:47]
  ds_read_b64_tr_b16 v[48:49], v9 offset:3584
  ds_read_b64_tr_b16 v[50:51], v9 offset:4608
  ds_read_b64_tr_b16 v[52:53], v10 offset:3584
  ds_read_b64_tr_b16 v[54:55], v10 offset:4608
  s_waitcnt vmcnt(14) lgkmcnt(4)
  v_mfma_f32_32x32x16_bf16 v[16:31], v[56:59], v[68:71], v[16:31]
  v_mfma_f32_32x32x16_bf16 v[32:47], v[60:63], v[68:71], v[32:47]
  ds_read_b64_tr_b16 v[56:57], v9 offset:5632
  ds_read_b64_tr_b16 v[58:59], v9 offset:6656
  ds_read_b64_tr_b16 v[60:61], v10 offset:5632
  ds_read_b64_tr_b16 v[62:63], v10 offset:6656
  s_waitcnt vmcnt(13) lgkmcnt(4)
  v_mfma_f32_32x32x16_bf16 v[16:31], v[48:51], v[72:75], v[16:31]
  v_mfma_f32_32x32x16_bf16 v[32:47], v[52:55], v[72:75], v[32:47]
  ds_read_b64_tr_b16 v[48:49], v9 offset:7168
  ds_read_b64_tr_b16 v[50:51], v9 offset:8192
  ds_read_b64_tr_b16 v[52:53], v10 offset:7168
  ds_read_b64_tr_b16 v[54:55], v10 offset:8192
  s_waitcnt vmcnt(12) lgkmcnt(4)
  v_mfma_f32_32x32x16_bf16 v[16:31], v[56:59], v[76:79], v[16:31]
  v_mfma_f32_32x32x16_bf16 v[32:47], v[60:63], v[76:79], v[32:47]
  ds_read_b64_tr_b16 v[56:57], v9 offset:9216
  ds_read_b64_tr_b16 v[58:59], v9 offset:10240
  ds_read_b64_tr_b16 v[60:61], v10 offset:9216
  ds_read_b64_tr_b16 v[62:63], v10 offset:10240
  s_waitcnt vmcnt(11) lgkmcnt(4)
  v_mfma_f32_32x32x16_bf16 v[16:31], v[48:51], v[80:83], v[16:31]
  v_mfma_f32_32x32x16_bf16 v[32:47], v[52:55], v[80:83], v[32:47]
  ds_read_b64_tr_b16 v[48:49], v9 offset:10752
  ds_read_b64_tr_b16 v[50:51], v9 offset:11776
  ds_read_b64_tr_b16 v[52:53], v10 offset:10752
  ds_read_b64_tr_b16 v[54:55], v10 offset:11776
  s_waitcnt vmcnt(10) lgkmcnt(4)
  v_mfma_f32_32x32x16_bf16 v[16:31], v[56:59], v[84:87], v[16:31]
  v_mfma_f32_32x32x16_bf16 v[32:47], v[60:63], v[84:87], v[32:47]
  ds_read_b64_tr_b16 v[56:57], v9 offset:12800
  ds_read_b64_tr_b16 v[58:59], v9 offset:13824
  ds_read_b64_tr_b16 v[60:61], v10 offset:12800
  ds_read_b64_tr_b16 v[62:63], v10 offset:13824
  s_waitcnt vmcnt(9) lgkmcnt(4)
  v_mfma_f32_32x32x16_bf16 v[16:31], v[48:51], v[88:91], v[16:31]
  v_mfma_f32_32x32x16_bf16 v[32:47], v[52:55], v[88:91], v[32:47]
  ds_read_b64_tr_b16 v[48:49], v9 offset:14336
  ds_read_b64_tr_b16 v[50:51], v9 offset:15360
  ds_read_b64_tr_b16 v[52:53], v10 offset:14336
  ds_read_b64_tr_b16 v[54:55], v10 offset:15360
  s_waitcnt vmcnt(8) lgkmcnt(4)
  v_mfma_f32_32x32x16_bf16 v[16:31], v[56:59], v[92:95], v[16:31]
  v_mfma_f32_32x32x16_bf16 v[32:47], v[60:63], v[92:95], v[32:47]
  ds_read_b64_tr_b16 v[56:57], v9 offset:16384
  ds_read_b64_tr_b16 v[58:59], v9 offset:17408
  ds_read_b64_tr_b16 v[60:61], v10 offset:16384
  ds_read_b64_tr_b16 v[62:63], v10 offset:17408
  s_waitcnt vmcnt(7) lgkmcnt(4)
  v_mfma_f32_32x32x16_bf16 v[16:31], v[48:51], v[96:99], v[16:31]
  v_mfma_f32_32x32x16_bf16 v[32:47], v[52:55], v[96:99], v[32:47]
  ds_read_b64_tr_b16 v[48:49], v9 offset:17920
  ds_read_b64_tr_b16 v[50:51], v9 offset:18944
  ds_read_b64_tr_b16 v[52:53], v10 offset:17920
  ds_read_b64_tr_b16 v[54:55], v10 offset:18944
  s_waitcnt vmcnt(6) lgkmcnt(4)
  v_mfma_f32_32x32x16_bf16 v[16:31], v[56:59], v[100:103], v[16:31]
  v_mfma_f32_32x32x16_bf16 v[32:47], v[60:63], v[100:103], v[32:47]
  ds_read_b64_tr_b16 v[56:57], v9 offset:19968
  ds_read_b64_tr_b16 v[58:59], v9 offset:20992
  ds_read_b64_tr_b16 v[60:61], v10 offset:19968
  ds_read_b64_tr_b16 v[62:63], v10 offset:20992
  s_waitcnt vmcnt(5) lgkmcnt(4)
  v_mfma_f32_32x32x16_bf16 v[16:31], v[48:51], v[104:107], v[16:31]
  v_mfma_f32_32x32x16_bf16 v[32:47], v[52:55], v[104:107], v[32:47]
  ds_read_b64_tr_b16 v[48:49], v9 offset:21504
  ds_read_b64_tr_b16 v[50:51], v9 offset:22528
  ds_read_b64_tr_b16 v[52:53], v10 offset:21504
  ds_read_b64_tr_b16 v[54:55], v10 offset:22528
  s_waitcnt vmcnt(4) lgkmcnt(4)
  v_mfma_f32_32x32x16_bf16 v[16:31], v[56:59], v[108:111], v[16:31]
  v_mfma_f32_32x32x16_bf16 v[32:47], v[60:63], v[108:111], v[32:47]
  ds_read_b64_tr_b16 v[56:57], v9 offset:23552
  ds_read_b64_tr_b16 v[58:59], v9 offset:24576
  ds_read_b64_tr_b16 v[60:61], v10 offset:23552
  ds_read_b64_tr_b16 v[62:63], v10 offset:24576
  s_waitcnt vmcnt(3) lgkmcnt(4)
  v_mfma_f32_32x32x16_bf16 v[16:31], v[48:51], v[112:115], v[16:31]
  v_mfma_f32_32x32x16_bf16 v[32:47], v[52:55], v[112:115], v[32:47]
  ds_read_b64_tr_b16 v[48:49], v9 offset:25088
  ds_read_b64_tr_b16 v[50:51], v9 offset:26112
  ds_read_b64_tr_b16 v[52:53], v10 offset:25088
  ds_read_b64_tr_b16 v[54:55], v10 offset:26112
  s_waitcnt vmcnt(2) lgkmcnt(4)
  v_mfma_f32_32x32x16_bf16 v[16:31], v[56:59], v[116:119], v[16:31]
  v_mfma_f32_32x32x16_bf16 v[32:47], v[60:63], v[116:119], v[32:47]
  ds_read_b64_tr_b16 v[56:57], v9 offset:27136
  ds_read_b64_tr_b16 v[58:59], v9 offset:28160
  ds_read_b64_tr_b16 v[60:61], v10 offset:27136
  ds_read_b64_tr_b16 v[62:63], v10 offset:28160
  s_waitcnt vmcnt(1) lgkmcnt(4)
  v_mfma_f32_32x32x16_bf16 v[16:31], v[48:51], v[120:123], v[16:31]
  v_mfma_f32_32x32x16_bf16 v[32:47], v[52:55], v[120:123], v[32:47]
  s_waitcnt vmcnt(0) lgkmcnt(0)
  v_mfma_f32_32x32x16_bf16 v[16:31], v[56:59], v[124:127], v[16:31]
  v_mfma_f32_32x32x16_bf16 v[32:47], v[60:63], v[124:127], v[32:47]
  v_lshlrev_b32 v5, 4, v1
  s_lshl_b32 s58, s3, 12
  s_add_u32 s58, s58, 0
  v_add_u32 v6, s58, v5
  s_xor_b32 s59, s3, 2
  s_lshl_b32 s59, s59, 12
  s_add_u32 s59, s59, 0
  v_add_u32 v7, s59, v5
  s_nop 7
  s_cmp_eq_u32 s57, 0
  s_cbranch_scc0 L_k1_118
  ds_write_b128 v6, v[32:35] offset:0
  ds_write_b128 v6, v[36:39] offset:1024
  ds_write_b128 v6, v[40:43] offset:2048
  ds_write_b128 v6, v[44:47] offset:3072
  s_branch L_k2_119
L_k1_118:
  ds_write_b128 v6, v[16:19] offset:0
  ds_write_b128 v6, v[20:23] offset:1024
  ds_write_b128 v6, v[24:27] offset:2048
  ds_write_b128 v6, v[28:31] offset:3072
  s_waitcnt lgkmcnt(0)
  v_mov_b32 v16, v32
  v_mov_b32 v17, v33
  v_mov_b32 v18, v34
  v_mov_b32 v19, v35
  v_mov_b32 v20, v36
  v_mov_b32 v21, v37
  v_mov_b32 v22, v38
  v_mov_b32 v23, v39
  v_mov_b32 v24, v40
  v_mov_b32 v25, v41
  v_mov_b32 v26, v42
  v_mov_b32 v27, v43
  v_mov_b32 v28, v44
  v_mov_b32 v29, v45
  v_mov_b32 v30, v46
  v_mov_b32 v31, v47
L_k2_119:
  s_waitcnt lgkmcnt(0)
  v_mov_b32 v160, 157212
  v_mov_b32 v161, 1
  s_mov_b64 exec, 1
  ds_add_u32 v160, v161
  s_mov_b64 exec, -1
  v_and_b32 v10, 31, v1
  s_lshl_b32 s58, s54, 6
  s_lshl_b32 s59, s56, 5
  s_add_u32 s58, s58, s59
  v_add_u32 v10, s58, v10
  v_mul_u32_u24 v10, 1792, v10
  v_lshrrev_b32 v11, 5, v1
  v_lshl_add_u32 v10, v11, 4, v10
  s_lshl_b32 s58, s55, 7
  s_lshl_b32 s59, s57, 6
  s_add_u32 s58, s58, s59
  s_add_u32 s58, s58, 896
  s_movk_i32 s95, 7
  s_lshl_b32 s94, s95, 2
  s_add_u32 s94, s94, 157184
  v_mov_b32 v160, s94
  s_mov_b32 s96, 0
L_ls_120:
  ds_read_b32 v161, v160
  s_add_u32 s96, s96, 1
  s_waitcnt lgkmcnt(0)
  v_readfirstlane_b32 s94, v161
  s_cmp_gt_u32 s96, 1048576
  s_cbranch_scc1 L_lsx_121
  s_cmp_ge_u32 s94, 4
  s_cbranch_scc1 L_lsx_121
  s_sleep 1
  s_branch L_ls_120
L_lsx_121:
  ds_read_b128 v[48:51], v7 offset:0
  ds_read_b128 v[52:55], v7 offset:1024
  ds_read_b128 v[56:59], v7 offset:2048
  ds_read_b128 v[60:63], v7 offset:3072
  s_waitcnt lgkmcnt(0)
  v_add_f32 v16, v16, v48
  v_add_f32 v17, v17, v49
  v_add_f32 v18, v18, v50
  v_add_f32 v19, v19, v51
  v_add_f32 v20, v20, v52
  v_add_f32 v21, v21, v53
  v_add_f32 v22, v22, v54
  v_add_f32 v23, v23, v55
  v_add_f32 v24, v24, v56
  v_add_f32 v25, v25, v57
  v_add_f32 v26, v26, v58
  v_add_f32 v27, v27, v59
  v_add_f32 v28, v28, v60
  v_add_f32 v29, v29, v61
  v_add_f32 v30, v30, v62
  v_add_f32 v31, v31, v63
  v_cvt_pk_bf16_f32 v64, v16, v17
  v_cvt_pk_bf16_f32 v65, v18, v19
  v_cvt_pk_bf16_f32 v66, v20, v21
  v_cvt_pk_bf16_f32 v67, v22, v23
  v_cvt_pk_bf16_f32 v68, v24, v25
  v_cvt_pk_bf16_f32 v69, v26, v27
  v_cvt_pk_bf16_f32 v70, v28, v29
  v_cvt_pk_bf16_f32 v71, v30, v31
  s_nop 1
  v_permlane32_swap_b32 v64, v66
  v_permlane32_swap_b32 v65, v67
  v_permlane32_swap_b32 v68, v70
  v_permlane32_swap_b32 v69, v71
  s_nop 1
  buffer_store_dwordx4 v[64:67], v10, s[44:47], s58 offen nt
  buffer_store_dwordx4 v[68:71], v10, s[44:47], s58 offen offset:32 nt
  s_branch L_tailend_107
L_no3_114:
  s_waitcnt vmcnt(0)
  v_mov_b32 v160, 157188
  v_mov_b32 v161, 1
  s_mov_b64 exec, 1
  ds_add_rtn_u32 v161, v160, v161
  s_waitcnt lgkmcnt(0)
  s_mov_b64 exec, -1
  v_readfirstlane_b32 s94, v161
  s_nop 3
  s_cmp_lg_u32 s94, 3
  s_cbranch_scc1 L_sl_122
  s_lshl_b32 s94, s58, 4
  s_add_u32 s94, s94, 13643776
  v_mov_b32 v160, s93
  v_mov_b32 v161, 0
  s_mov_b64 exec, 1
  buffer_store_dword v160, v161, s[4:7], s94 offen sc1
  s_mov_b64 exec, -1
L_sl_122:
  s_branch L_tailend_107
L_fallback_108:
  s_waitcnt vmcnt(0) lgkmcnt(0)
  s_mov_b32 s101, 1
  s_barrier
  v_mov_b32 v8, 0xff800000
  s_lshl_b32 s88, s52, 18
  s_add_u32 s88, s88, s58
  s_add_u32 s88, s88, 2097152
  s_mov_b32 s89, 0
  v_add_u32 v2, s59, v4
L_fbloop_123:
  s_mov_b32 m0, s58
  s_nop 0
  buffer_load_dwordx4 v4, s[4:7], s88 offen offset:0 sc1 lds
  buffer_load_dwordx4 v4, s[4:7], s88 offen offset:1024 sc1 lds
  s_waitcnt vmcnt(0)
  s_barrier
  ds_read_b128 v[72:75], v2 offset:0
  ds_read_b128 v[76:79], v2 offset:1024
  s_waitcnt lgkmcnt(0)
  v_mfma_f32_32x32x16_bf16 v[32:47], v[72:75], v[144:147], 0
  v_mfma_f32_32x32x16_bf16 v[32:47], v[76:79], v[148:151], v[32:47]
  s_nop 15
  s_nop 3
  v_max3_f32 v8, v8, v32, v33
  v_max3_f32 v8, v8, v34, v35
  v_max3_f32 v8, v8, v36, v37
  v_max3_f32 v8, v8, v38, v39
  v_max3_f32 v8, v8, v40, v41
  v_max3_f32 v8, v8, v42, v43
  v_max3_f32 v8, v8, v44, v45
  v_max3_f32 v8, v8, v46, v47
  ds_read_b128 v[72:75], v2 offset:4096
  ds_read_b128 v[76:79], v2 offset:5120
  s_waitcnt lgkmcnt(0)
  v_mfma_f32_32x32x16_bf16 v[32:47], v[72:75], v[144:147], 0
  v_mfma_f32_32x32x16_bf16 v[32:47], v[76:79], v[148:151], v[32:47]
  s_nop 15
  s_nop 3
  v_max3_f32 v8, v8, v32, v33
  v_max3_f32 v8, v8, v34, v35
  v_max3_f32 v8, v8, v36, v37
  v_max3_f32 v8, v8, v38, v39
  v_max3_f32 v8, v8, v40, v41
  v_max3_f32 v8, v8, v42, v43
  v_max3_f32 v8, v8, v44, v45
  v_max3_f32 v8, v8, v46, v47
  ds_read_b128 v[72:75], v2 offset:8192
  ds_read_b128 v[76:79], v2 offset:9216
  s_waitcnt lgkmcnt(0)
  v_mfma_f32_32x32x16_bf16 v[32:47], v[72:75], v[144:147], 0
  v_mfma_f32_32x32x16_bf16 v[32:47], v[76:79], v[148:151], v[32:47]
  s_nop 15
  s_nop 3
  v_max3_f32 v8, v8, v32, v33
  v_max3_f32 v8, v8, v34, v35
  v_max3_f32 v8, v8, v36, v37
  v_max3_f32 v8, v8, v38, v39
  v_max3_f32 v8, v8, v40, v41
  v_max3_f32 v8, v8, v42, v43
  v_max3_f32 v8, v8, v44, v45
  v_max3_f32 v8, v8, v46, v47
  ds_read_b128 v[72:75], v2 offset:12288
  ds_read_b128 v[76:79], v2 offset:13312
  s_waitcnt lgkmcnt(0)
  v_mfma_f32_32x32x16_bf16 v[32:47], v[72:75], v[144:147], 0
  v_mfma_f32_32x32x16_bf16 v[32:47], v[76:79], v[148:151], v[32:47]
  s_nop 15
  s_nop 3
  v_max3_f32 v8, v8, v32, v33
  v_max3_f32 v8, v8, v34, v35
  v_max3_f32 v8, v8, v36, v37
  v_max3_f32 v8, v8, v38, v39
  v_max3_f32 v8, v8, v40, v41
  v_max3_f32 v8, v8, v42, v43
  v_max3_f32 v8, v8, v44, v45
  v_max3_f32 v8, v8, v46, v47
  s_barrier
  s_add_u32 s88, s88, 32768
  s_add_u32 s89, s89, 1
  s_cmp_lt_u32 s89, 8
  s_cbranch_scc1 L_fbloop_123
  v_mov_b32 v6, v8
  v_mov_b32 v7, v8
  s_nop 1
  v_permlane32_swap_b32 v6, v7
  s_nop 1
  v_max_f32 v8, v6, v7
  v_lshlrev_b32 v5, 2, v1
  s_lshl_b32 s88, s3, 8
  s_add_u32 s88, s88, 81920
  v_add_u32 v6, s88, v5
  s_xor_b32 s88, s3, 4
  s_lshl_b32 s88, s88, 8
  s_add_u32 s88, s88, 81920
  v_add_u32 v7, s88, v5
  ds_write_b32 v6, v8
  s_waitcnt lgkmcnt(0)
  s_barrier
  ds_read_b32 v9, v7
  s_waitcnt lgkmcnt(0)
  v_max_f32 v8, v8, v9
  v_sub_f32 v16, 0, v8
  v_sub_f32 v17, 0, v8
  v_sub_f32 v18, 0, v8
  v_sub_f32 v19, 0, v8
  v_sub_f32 v20, 0, v8
  v_sub_f32 v21, 0, v8
  v_sub_f32 v22, 0, v8
  v_sub_f32 v23, 0, v8
  v_sub_f32 v24, 0, v8
  v_sub_f32 v25, 0, v8
  v_sub_f32 v26, 0, v8
  v_sub_f32 v27, 0, v8
  v_sub_f32 v28, 0, v8
  v_sub_f32 v29, 0, v8
  v_sub_f32 v30, 0, v8
  v_sub_f32 v31, 0, v8
  s_lshl_b32 s57, s52, 18
  s_add_u32 s57, s57, s58
  s_add_u32 s57, s57, 2162688
  s_mov_b32 s56, 0x00300030
  v_add_u32 v2, s59, v4
  v_add_u32 v3, 32768, v2
  v_mov_b32 v88, 0
  v_mov_b32 v89, 0
  v_mov_b32 v90, 0
  v_mov_b32 v91, 0
  v_mov_b32 v92, 0
  v_mov_b32 v93, 0
  v_mov_b32 v94, 0
  v_mov_b32 v95, 0
  v_mov_b32 v96, 0
  v_mov_b32 v97, 0
  v_mov_b32 v98, 0
  v_mov_b32 v99, 0
  v_mov_b32 v100, 0
  v_mov_b32 v101, 0
  v_mov_b32 v102, 0
  v_mov_b32 v103, 0
  v_mov_b32 v68, 0
  v_mov_b32 v69, 0
  v_mov_b32 v70, 0
  v_mov_b32 v71, 0
  s_mov_b32 s60, 65536
  s_mov_b32 s61, 0
  s_mov_b32 s98, 0
  s_sub_u32 s88, s57, 65536
  s_mov_b32 m0, s58
  s_nop 0
  buffer_load_dwordx4 v4, s[4:7], s88 offen offset:0 sc1 lds
  buffer_load_dwordx4 v4, s[4:7], s88 offen offset:1024 sc1 lds
  buffer_load_dwordx4 v4, s[4:7], s88 offen offset:2048 sc1 lds
  buffer_load_dwordx4 v4, s[4:7], s88 offen offset:3072 sc1 lds
  s_waitcnt vmcnt(0)
  s_barrier
  ds_read_b128 v[72:75], v2 offset:0
  ds_read_b128 v[76:79], v2 offset:1024
  s_sub_u32 s88, s57, 32768
  s_add_u32 m0, s58, 32768
  s_nop 0
  buffer_load_dwordx4 v4, s[4:7], s88 offen offset:0 sc1 lds
  buffer_load_dwordx4 v4, s[4:7], s88 offen offset:1024 sc1 lds
  buffer_load_dwordx4 v4, s[4:7], s88 offen offset:2048 sc1 lds
  buffer_load_dwordx4 v4, s[4:7], s88 offen offset:3072 sc1 lds
  s_waitcnt lgkmcnt(0)
  v_mfma_f32_32x32x16_bf16 v[32:47], v[72:75], v[144:147], v[16:31]
  v_mfma_f32_32x32x16_bf16 v[32:47], v[76:79], v[148:151], v[32:47]
  ds_read_b128 v[72:75], v2 offset:4096
  ds_read_b128 v[84:87], v2 offset:3072
  ds_read_b128 v[76:79], v2 offset:5120
  ds_read_b128 v[80:83], v2 offset:2048
  s_nop 7
  s_setprio 1
  s_cmp_lt_u32 s3, 4
  s_cbranch_scc1 L_sp_124
  s_setprio 2
L_sp_124:
.p2align 6
L_atloop_125:
  s_waitcnt lgkmcnt(2)
  v_mfma_f32_32x32x16_bf16 v[48:63], v[72:75], v[144:147], v[16:31]
  ds_read_b128 v[72:75], v2 offset:8192
  v_exp_f32 v32, v32
  v_exp_f32 v33, v33
  v_exp_f32 v34, v34
  v_exp_f32 v35, v35
  v_mfma_f32_32x32x16_bf16 v[88:103], v[84:87], v[68:71], v[88:103]
  ds_read_b128 v[84:87], v2 offset:3072
  v_exp_f32 v36, v36
  v_exp_f32 v37, v37
  v_cvt_pk_bf16_f32 v64, v32, v33
  v_cvt_pk_bf16_f32 v65, v34, v35
  v_exp_f32 v38, v38
  s_waitcnt lgkmcnt(2)
  v_mfma_f32_32x32x16_bf16 v[48:63], v[76:79], v[148:151], v[48:63]
  ds_read_b128 v[76:79], v2 offset:9216
  v_exp_f32 v39, v39
  v_exp_f32 v40, v40
  v_cvt_pk_bf16_f32 v66, v36, v37
  v_exp_f32 v41, v41
  v_exp_f32 v42, v42
  v_cvt_pk_bf16_f32 v67, v38, v39
  v_exp_f32 v43, v43
  v_exp_f32 v44, v44
  v_mfma_f32_32x32x16_bf16 v[88:103], v[80:83], v[64:67], v[88:103]
  ds_read_b128 v[80:83], v2 offset:6144
  v_exp_f32 v45, v45
  v_exp_f32 v46, v46
  v_exp_f32 v47, v47
  v_cvt_pk_bf16_f32 v68, v40, v41
  v_cvt_pk_bf16_f32 v69, v42, v43
  v_cvt_pk_bf16_f32 v70, v44, v45
  v_cvt_pk_bf16_f32 v71, v46, v47
  s_waitcnt lgkmcnt(2)
  v_mfma_f32_32x32x16_bf16 v[32:47], v[72:75], v[144:147], v[16:31]
  ds_read_b128 v[72:75], v2 offset:12288
  v_exp_f32 v48, v48
  v_exp_f32 v49, v49
  v_exp_f32 v50, v50
  v_exp_f32 v51, v51
  v_mfma_f32_32x32x16_bf16 v[88:103], v[84:87], v[68:71], v[88:103]
  ds_read_b128 v[84:87], v2 offset:7168
  v_exp_f32 v52, v52
  v_exp_f32 v53, v53
  v_cvt_pk_bf16_f32 v64, v48, v49
  v_cvt_pk_bf16_f32 v65, v50, v51
  v_exp_f32 v54, v54
  s_waitcnt lgkmcnt(2)
  v_mfma_f32_32x32x16_bf16 v[32:47], v[76:79], v[148:151], v[32:47]
  ds_read_b128 v[76:79], v2 offset:13312
  v_exp_f32 v55, v55
  v_exp_f32 v56, v56
  v_cvt_pk_bf16_f32 v66, v52, v53
  v_exp_f32 v57, v57
  v_exp_f32 v58, v58
  v_cvt_pk_bf16_f32 v67, v54, v55
  v_exp_f32 v59, v59
  v_exp_f32 v60, v60
  v_mfma_f32_32x32x16_bf16 v[88:103], v[80:83], v[64:67], v[88:103]
  ds_read_b128 v[80:83], v2 offset:10240
  v_exp_f32 v61, v61
  v_exp_f32 v62, v62
  v_exp_f32 v63, v63
  v_cvt_pk_bf16_f32 v68, v56, v57
  v_cvt_pk_bf16_f32 v69, v58, v59
  v_cvt_pk_bf16_f32 v70, v60, v61
  v_cvt_pk_bf16_f32 v71, v62, v63
  s_waitcnt vmcnt(0)
  s_barrier
  s_add_u32 m0, s58, s60
  s_nop 0
  s_waitcnt lgkmcnt(2)
  v_mfma_f32_32x32x16_bf16 v[48:63], v[72:75], v[144:147], v[16:31]
  ds_read_b128 v[72:75], v3 offset:0
  s_cmp_ge_u32 s61, 6
  s_cbranch_scc1 L_nokv_126
  buffer_load_dwordx4 v4, s[4:7], s57 offen offset:0 sc1 lds
L_nokv_126:
  v_exp_f32 v32, v32
  v_exp_f32 v33, v33
  v_exp_f32 v34, v34
  v_exp_f32 v35, v35
  v_mfma_f32_32x32x16_bf16 v[88:103], v[84:87], v[68:71], v[88:103]
  ds_read_b128 v[84:87], v2 offset:11264
  v_exp_f32 v36, v36
  v_exp_f32 v37, v37
  v_cvt_pk_bf16_f32 v64, v32, v33
  v_cvt_pk_bf16_f32 v65, v34, v35
  v_exp_f32 v38, v38
  s_waitcnt lgkmcnt(2)
  v_mfma_f32_32x32x16_bf16 v[48:63], v[76:79], v[148:151], v[48:63]
  ds_read_b128 v[76:79], v3 offset:1024
  s_cmp_ge_u32 s61, 6
  s_cbranch_scc1 L_nokv_127
  buffer_load_dwordx4 v4, s[4:7], s57 offen offset:1024 sc1 lds
L_nokv_127:
  v_exp_f32 v39, v39
  v_exp_f32 v40, v40
  v_cvt_pk_bf16_f32 v66, v36, v37
  v_exp_f32 v41, v41
  v_exp_f32 v42, v42
  v_cvt_pk_bf16_f32 v67, v38, v39
  v_exp_f32 v43, v43
  v_exp_f32 v44, v44
  v_mfma_f32_32x32x16_bf16 v[88:103], v[80:83], v[64:67], v[88:103]
  ds_read_b128 v[80:83], v2 offset:14336
  v_exp_f32 v45, v45
  v_exp_f32 v46, v46
  v_exp_f32 v47, v47
  v_cvt_pk_bf16_f32 v68, v40, v41
  v_cvt_pk_bf16_f32 v69, v42, v43
  v_cvt_pk_bf16_f32 v70, v44, v45
  v_cvt_pk_bf16_f32 v71, v46, v47
  s_waitcnt lgkmcnt(2)
  v_mfma_f32_32x32x16_bf16 v[32:47], v[72:75], v[144:147], v[16:31]
  ds_read_b128 v[72:75], v3 offset:4096
  s_cmp_ge_u32 s61, 6
  s_cbranch_scc1 L_nokv_128
  buffer_load_dwordx4 v4, s[4:7], s57 offen offset:2048 sc1 lds
L_nokv_128:
  v_exp_f32 v48, v48
  v_exp_f32 v49, v49
  v_exp_f32 v50, v50
  v_exp_f32 v51, v51
  v_mfma_f32_32x32x16_bf16 v[88:103], v[84:87], v[68:71], v[88:103]
  ds_read_b128 v[84:87], v2 offset:15360
  v_exp_f32 v52, v52
  v_exp_f32 v53, v53
  v_cvt_pk_bf16_f32 v64, v48, v49
  v_cvt_pk_bf16_f32 v65, v50, v51
  v_exp_f32 v54, v54
  s_waitcnt lgkmcnt(2)
  v_mfma_f32_32x32x16_bf16 v[32:47], v[76:79], v[148:151], v[32:47]
  ds_read_b128 v[76:79], v3 offset:5120
  s_cmp_ge_u32 s61, 6
  s_cbranch_scc1 L_nokv_129
  buffer_load_dwordx4 v4, s[4:7], s57 offen offset:3072 sc1 lds
L_nokv_129:
  v_exp_f32 v55, v55
  v_exp_f32 v56, v56
  v_cvt_pk_bf16_f32 v66, v52, v53
  v_exp_f32 v57, v57
  v_exp_f32 v58, v58
  v_cvt_pk_bf16_f32 v67, v54, v55
  v_exp_f32 v59, v59
  v_exp_f32 v60, v60
  v_mfma_f32_32x32x16_bf16 v[88:103], v[80:83], v[64:67], v[88:103]
  ds_read_b128 v[80:83], v3 offset:2048
  v_exp_f32 v61, v61
  v_exp_f32 v62, v62
  v_exp_f32 v63, v63
  v_cvt_pk_bf16_f32 v68, v56, v57
  v_cvt_pk_bf16_f32 v69, v58, v59
  v_cvt_pk_bf16_f32 v70, v60, v61
  v_cvt_pk_bf16_f32 v71, v62, v63
  s_add_u32 s57, s57, 32768
  s_add_u32 s60, s60, 32768
  s_cmp_eq_u32 s60, 98304
  s_cselect_b32 s60, 0, s60
  v_mov_b32 v2, v3
  s_add_u32 s88, s60, 65536
  s_cmp_ge_u32 s88, 98304
  s_cselect_b32 s89, 98304, 0
  s_sub_u32 s88, s88, s89
  s_add_u32 s88, s88, s59
  v_add_u32 v3, s88, v4
  s_add_u32 s61, s61, 1
  s_cmp_lt_u32 s61, 8
  s_cbranch_scc1 L_atloop_125
  s_setprio 0
  s_waitcnt vmcnt(0) lgkmcnt(0)
  v_mfma_f32_32x32x16_bf16 v[88:103], v[84:87], v[68:71], v[88:103]
  s_cmp_eq_u32 s55, 0
  s_cbranch_scc1 L_c0_130
  s_nop 11
  ds_write_b128 v157, v[88:91] offset:0
  ds_write_b128 v157, v[92:95] offset:1024
  ds_write_b128 v157, v[96:99] offset:2048
  ds_write_b128 v157, v[100:103] offset:3072
  s_waitcnt lgkmcnt(0)
L_c0_130:
  s_barrier
  s_branch L_tailtop_105
L_tailh_106:
  s_cmp_lg_u32 s101, 0
  s_cbranch_scc1 L_vd_131
  s_movk_i32 s95, 27
  s_lshl_b32 s94, s95, 2
  s_add_u32 s94, s94, 157184
  v_mov_b32 v160, s94
  s_mov_b32 s96, 0
L_ls_132:
  ds_read_b32 v161, v160
  s_add_u32 s96, s96, 1
  s_waitcnt lgkmcnt(0)
  v_readfirstlane_b32 s94, v161
  s_cmp_gt_u32 s96, 1048576
  s_cbranch_scc1 L_lsx_133
  s_cmp_ge_u32 s94, 4
  s_cbranch_scc1 L_lsx_133
  s_sleep 1
  s_branch L_ls_132
L_lsx_133:
  v_mov_b32 v160, 157300
  ds_read_b32 v161, v160
  s_waitcnt lgkmcnt(0)
  v_readfirstlane_b32 s94, v161
  s_nop 3
  s_cmp_lg_u32 s94, 0
  s_cbranch_scc1 L_fallback_108
L_vd_131:
  s_cmp_ge_u32 s2, 224
  s_cbranch_scc1 L_tailend_107
  s_sub_u32 s63, s3, 4
  s_and_b32 s88, s2, 7
  s_lshr_b32 s89, s2, 3
  s_mul_i32 s90, s89, 9363
  s_lshr_b32 s90, s90, 16
  s_mul_i32 s91, s90, 7
  s_sub_u32 s59, s89, s91
  s_lshl_b32 s88, s88, 2
  s_add_u32 s58, s90, s88
  v_lshrrev_b32 v128, 3, v1
  s_lshl_b32 s88, s58, 6
  s_lshl_b32 s89, s63, 4
  s_add_u32 s88, s88, s89
  v_add_u32 v128, s88, v128
  v_and_b32 v129, 7, v1
  v_lshlrev_b32 v129, 4, v129
  s_lshl_b32 s88, s59, 7
  v_add_u32 v129, s88, v129
  v_mul_u32_u24 v130, 896, v128
  v_add_u32 v130, v130, v129
  buffer_load_dwordx4 v[132:135], v130, s[28:31], 0 offen
  v_add_u32 v130, 7168, v130
  buffer_load_dwordx4 v[136:139], v130, s[28:31], 0 offen
  v_mul_u32_u24 v131, 1792, v128
  v_add_u32 v131, v131, v129
  s_lshl_b32 s57, s59, 5
  v_and_b32 v2, 31, v1
  v_add_u32 v2, s57, v2
  v_lshlrev_b32 v2, 4, v2
  v_add_u32 v2, 13639680, v2
  v_lshrrev_b32 v4, 1, v1
  v_and_b32 v3, 1, v1
  v_lshlrev_b32 v3, 4, v3
  v_lshl_add_u32 v6, v4, 12, v3
  s_lshl_b32 s57, s59, 18
  s_lshl_b32 s60, s58, 7
  s_add_u32 s57, s57, s60
  s_lshl_b32 s60, s63, 5
  s_add_u32 s57, s57, s60
  s_add_u32 s57, s57, 8388608
  s_lshl_b32 s60, s63, 12
  s_add_u32 s60, s60, 16384
  v_lshrrev_b32 v14, 4, v1
  v_bfe_u32 v15, v1, 2, 2
  v_lshl_add_u32 v14, v14, 3, v15
  v_lshlrev_b32 v14, 5, v14
  v_and_b32 v24, 3, v1
  v_lshl_add_u32 v14, v24, 3, v14
  v_add_u32 v14, s60, v14
  v_and_b32 v24, 15, v1
  v_lshrrev_b32 v25, 4, v1
  v_and_b32 v26, 7, v24
  v_xor_b32 v25, v25, v26
  v_xor_b32 v26, 4, v25
  s_add_u32 s61, s60, 2048
  v_lshlrev_b32 v24, 7, v24
  v_add_u32 v24, s61, v24
  v_lshl_add_u32 v25, v25, 4, v24
  v_lshl_add_u32 v26, v26, 4, v24
  v_lshrrev_b32 v27, 3, v1
  v_and_b32 v28, 7, v1
  v_xor_b32 v28, v28, v27
  v_lshlrev_b32 v28, 4, v28
  v_lshl_add_u32 v28, v27, 7, v28
  v_add_u32 v28, s61, v28
  s_mov_b32 s94, 0
L_poll_134:
  buffer_load_dword v162, v2, s[4:7], 0 offen sc1
  s_add_u32 s94, s94, 1
  s_cmp_gt_u32 s94, 65536
  s_waitcnt vmcnt(0)
  s_cbranch_scc1 L_pollx_135
  v_cmp_ne_u32 vcc, s93, v162
  s_cbranch_vccz L_pollx_135
  s_sleep 1
  s_branch L_poll_134
L_pollx_135:
  s_mov_b32 m0, s60
  s_nop 0
  buffer_load_dwordx4 v6, s[4:7], s57 offen sc1 lds
  s_add_u32 m0, s60, 1024
  s_add_u32 s57, s57, 131072
  buffer_load_dwordx4 v6, s[4:7], s57 offen sc1 lds
  s_waitcnt vmcnt(0)
  ds_read_b64_tr_b16 v[32:33], v14 offset:0
  ds_read_b64_tr_b16 v[34:35], v14 offset:128
  ds_read_b64_tr_b16 v[36:37], v14 offset:1024
  ds_read_b64_tr_b16 v[38:39], v14 offset:1152
  s_waitcnt lgkmcnt(0)
  ds_write_b128 v25, v[32:35]
  ds_write_b128 v26, v[36:39]
  s_waitcnt lgkmcnt(0)
  ds_read_b128 v[40:43], v28
  ds_read_b128 v[44:47], v28 offset:1024
  s_waitcnt lgkmcnt(0)
  v_lshlrev_b32 v48, 16, v40
  v_and_b32 v49, 0xffff0000, v40
  v_lshlrev_b32 v50, 16, v132
  v_and_b32 v51, 0xffff0000, v132
  v_mul_f32 v48, v48, v50
  v_mul_f32 v49, v49, v51
  v_cvt_pk_bf16_f32 v52, v48, v49
  v_lshlrev_b32 v48, 16, v41
  v_and_b32 v49, 0xffff0000, v41
  v_lshlrev_b32 v50, 16, v133
  v_and_b32 v51, 0xffff0000, v133
  v_mul_f32 v48, v48, v50
  v_mul_f32 v49, v49, v51
  v_cvt_pk_bf16_f32 v53, v48, v49
  v_lshlrev_b32 v48, 16, v42
  v_and_b32 v49, 0xffff0000, v42
  v_lshlrev_b32 v50, 16, v134
  v_and_b32 v51, 0xffff0000, v134
  v_mul_f32 v48, v48, v50
  v_mul_f32 v49, v49, v51
  v_cvt_pk_bf16_f32 v54, v48, v49
  v_lshlrev_b32 v48, 16, v43
  v_and_b32 v49, 0xffff0000, v43
  v_lshlrev_b32 v50, 16, v135
  v_and_b32 v51, 0xffff0000, v135
  v_mul_f32 v48, v48, v50
  v_mul_f32 v49, v49, v51
  v_cvt_pk_bf16_f32 v55, v48, v49
  v_lshlrev_b32 v48, 16, v44
  v_and_b32 v49, 0xffff0000, v44
  v_lshlrev_b32 v50, 16, v136
  v_and_b32 v51, 0xffff0000, v136
  v_mul_f32 v48, v48, v50
  v_mul_f32 v49, v49, v51
  v_cvt_pk_bf16_f32 v56, v48, v49
  v_lshlrev_b32 v48, 16, v45
  v_and_b32 v49, 0xffff0000, v45
  v_lshlrev_b32 v50, 16, v137
  v_and_b32 v51, 0xffff0000, v137
  v_mul_f32 v48, v48, v50
  v_mul_f32 v49, v49, v51
  v_cvt_pk_bf16_f32 v57, v48, v49
  v_lshlrev_b32 v48, 16, v46
  v_and_b32 v49, 0xffff0000, v46
  v_lshlrev_b32 v50, 16, v138
  v_and_b32 v51, 0xffff0000, v138
  v_mul_f32 v48, v48, v50
  v_mul_f32 v49, v49, v51
  v_cvt_pk_bf16_f32 v58, v48, v49
  v_lshlrev_b32 v48, 16, v47
  v_and_b32 v49, 0xffff0000, v47
  v_lshlrev_b32 v50, 16, v139
  v_and_b32 v51, 0xffff0000, v139
  v_mul_f32 v48, v48, v50
  v_mul_f32 v49, v49, v51
  v_cvt_pk_bf16_f32 v59, v48, v49
  buffer_store_dwordx4 v[52:55], v131, s[44:47], 0 offen nt
  v_add_u32 v131, 14336, v131
  buffer_store_dwordx4 v[56:59], v131, s[44:47], 0 offen nt
L_tailend_107:
  s_cmp_lg_u32 s2, 255
  s_cbranch_scc1 L_fin_136
  s_cmp_lg_u32 s3, 0
  s_cbranch_scc1 L_fin_136
  v_lshlrev_b32 v2, 4, v1
  v_add_u32 v2, 13635584, v2
  s_mov_b32 s94, 0
L_poll_137:
  buffer_load_dword v162, v2, s[4:7], 0 offen sc1
  s_add_u32 s94, s94, 1
  s_cmp_gt_u32 s94, 65536
  s_waitcnt vmcnt(0)
  s_cbranch_scc1 L_pollx_138
  v_cmp_ne_u32 vcc, s93, v162
  s_cbranch_vccz L_pollx_138
  s_sleep 1
  s_branch L_poll_137
L_pollx_138:
  v_lshlrev_b32 v2, 4, v1
  v_add_u32 v2, 13636608, v2
  s_mov_b32 s94, 0
L_poll_139:
  buffer_load_dword v162, v2, s[4:7], 0 offen sc1
  s_add_u32 s94, s94, 1
  s_cmp_gt_u32 s94, 65536
  s_waitcnt vmcnt(0)
  s_cbranch_scc1 L_pollx_140
  v_cmp_ne_u32 vcc, s93, v162
  s_cbranch_vccz L_pollx_140
  s_sleep 1
  s_branch L_poll_139
L_pollx_140:
  v_lshlrev_b32 v2, 4, v1
  v_add_u32 v2, 13637632, v2
  s_mov_b32 s94, 0
L_poll_141:
  buffer_load_dword v162, v2, s[4:7], 0 offen sc1
  s_add_u32 s94, s94, 1
  s_cmp_gt_u32 s94, 65536
  s_waitcnt vmcnt(0)
  s_cbranch_scc1 L_pollx_142
  v_cmp_ne_u32 vcc, s93, v162
  s_cbranch_vccz L_pollx_142
  s_sleep 1
  s_branch L_poll_141
L_pollx_142:
  v_lshlrev_b32 v2, 4, v1
  v_add_u32 v2, 13638656, v2
  s_mov_b32 s94, 0
L_poll_143:
  buffer_load_dword v162, v2, s[4:7], 0 offen sc1
  s_add_u32 s94, s94, 1
  s_cmp_gt_u32 s94, 65536
  s_waitcnt vmcnt(0)
  s_cbranch_scc1 L_pollx_144
  v_cmp_ne_u32 vcc, s93, v162
  s_cbranch_vccz L_pollx_144
  s_sleep 1
  s_branch L_poll_143
L_pollx_144:
  s_add_u32 s94, s63, 1
  v_mov_b32 v160, s94
  v_mov_b32 v161, 13647872
  s_mov_b64 exec, 1
  buffer_store_dword v160, v161, s[4:7], 0 offen sc1
  s_mov_b64 exec, -1
L_fin_136:
L_exit:
  s_endpgm
L_code_end:
.section .rodata,"a"
.p2align 6
.amdhsa_kernel concat_heads__ssm_conv_h3__softmax_full_mha__prompt_kernel
  .amdhsa_next_free_vgpr 168
  .amdhsa_next_free_sgpr 102
  .amdhsa_accum_offset 168
  .amdhsa_group_segment_fixed_size 0
  .amdhsa_kernarg_size 96
  .amdhsa_user_sgpr_count 2
  .amdhsa_user_sgpr_kernarg_segment_ptr 1
  .amdhsa_system_sgpr_workgroup_id_x 1
.end_amdhsa_kernel
```
